```python
import torch

def _softmax(x, axis=-1):
    return torch.softmax(x, dim=axis)

def _gelu(x):
    return torch.nn.functional.gelu(x, approximate='tanh')

def _silu(x):
    return torch.nn.functional.silu(x)

def _sigmoid(x):
    return torch.sigmoid(x)

def _layernorm(x, axis=-1, eps=1e-05):
    m = x.mean(dim=axis, keepdim=True)
    v = x.var(dim=axis, keepdim=True, unbiased=False)
    return (x - m) / torch.sqrt(v + eps)

def _scatter_add(tgt, idx, src, axis=0):
    return tgt.clone().index_add_(axis, idx, src)

def _segment_sum(src, seg, n):
    out = torch.zeros((n,) + src.shape[1:], dtype=src.dtype)
    return out.index_add_(0, seg, src)

def _pad(x, pw):
    flat = tuple((v for pair in reversed(pw) for v in pair))
    return torch.nn.functional.pad(x, flat)
kernel_name = 'adaLN_cond__gqa_block_cached__glu_gated_geglu__prompt'

def setup_inputs():

    _w = lambda a: (lambda t: t.to(torch.bfloat16) if t.is_floating_point() else t)(torch.as_tensor(a))

    def _A_setup():
        B, Sq, D = (1, 2048, 512)
        Hq, Hkv, Sk, Dh = (32, 8, 2048, 128)
        assert Hq % Hkv == 0, (Hq, Hkv)
        return {'x': _w((lambda *s: torch.randn(*s, dtype=torch.bfloat16) * 0.05)(B, Sq, D)), 'k_cache': _w((lambda *s: torch.randn(*s, dtype=torch.bfloat16) * 0.8)(B, Hkv, Sk, Dh)), 'v_cache': _w((lambda *s: torch.randn(*s, dtype=torch.bfloat16) * 3.2)(B, Hkv, Sk, Dh)), 'wq': _w((lambda *s: torch.randn(*s, dtype=torch.bfloat16) * 0.8)(D, Hq * Dh) * D ** (-0.5)), 'wo': _w((lambda *s: torch.randn(*s, dtype=torch.bfloat16) * 3.2)(Hq * Dh, D) * (Hq * Dh) ** (-0.5))}
    _A_in = _A_setup()

    def _B_setup():
        B, S, Dm, Df = (1, 2048, 512, 1792)
        return {'x': _w((lambda *s: torch.randn(*s, dtype=torch.bfloat16) * 0.05)(B, S, Dm)), 'w_gate': _w((lambda *s: torch.randn(*s, dtype=torch.bfloat16) * 3.2)(Dm, Df) * Dm ** (-0.5)), 'w_up': _w((lambda *s: torch.randn(*s, dtype=torch.bfloat16) * 3.2)(Dm, Df) * Dm ** (-0.5)), 'w_down': _w((lambda *s: torch.randn(*s, dtype=torch.bfloat16) * 3.2)(Df, Dm) * Df ** (-0.5))}
    _B_in = _B_setup()
    return {'A_x': _A_in['x'], 'A_k_cache': _A_in['k_cache'], 'A_v_cache': _A_in['v_cache'], 'A_wq': _A_in['wq'], 'A_wo': _A_in['wo'], 'B_x': _B_in['x'], 'B_w_gate': _B_in['w_gate'], 'B_w_up': _B_in['w_up'], 'B_w_down': _B_in['w_down'], 'c': _w((lambda *s: torch.randn(*s, dtype=torch.bfloat16) * 0.4)(1, 512) * 8.0), 'w_mod': _w((lambda *s: torch.randn(*s, dtype=torch.bfloat16) * 0.4)(512, 6 * 512) * 512 ** (-0.5) * 8.0)}

def reference(A_x, A_k_cache, A_v_cache, A_wq, A_wo, B_x, B_w_gate, B_w_up, B_w_down, c, w_mod):

    def _A_ref(x, k_cache, v_cache, wq, wo):
        B, Sq, D = x.shape
        Hq, Dh = (32, 128)
        Hkv = k_cache.shape[1]
        rep = Hq // Hkv
        q = (lambda x, *d: x.permute(*d))((x @ wq).reshape(B, Sq, Hq, Dh), 0, 2, 1, 3)
        k = (lambda x, n, axis: torch.repeat_interleave(x, n, dim=axis))(k_cache, rep, axis=1)
        v = (lambda x, n, axis: torch.repeat_interleave(x, n, dim=axis))(v_cache, rep, axis=1)
        scores = torch.einsum('bhqd,bhkd->bhqk', q, k) * Dh ** (-0.5)
        p = _softmax(scores, axis=-1)
        o = torch.einsum('bhqk,bhkd->bhqd', p, v)
        return (lambda x, *d: x.permute(*d))(o, 0, 2, 1, 3).reshape(B, Sq, Hq * Dh) @ wo

    def _B_ref(x, w_gate, w_up, w_down):
        g = torch.einsum('bsd,df->bsf', x, w_gate)
        u = torch.einsum('bsd,df->bsf', x, w_up)
        h = _gelu(g) * u
        return torch.einsum('bsf,fd->bsd', h, w_down)
    x = A_x
    mod = (_silu(c) @ w_mod).reshape(c.shape[0], 6, 1, -1)
    sa, ca, ga, sb, cb, gb = (mod[:, 0].clone(), mod[:, 1].clone(), mod[:, 2].clone(), mod[:, 3].clone(), mod[:, 4].clone(), mod[:, 5].clone())
    h = _layernorm(x, axis=-1) * (1 + ca) + sa
    x = x + ga * _A_ref(h, A_k_cache, A_v_cache, A_wq, A_wo)
    h = _layernorm(x, axis=-1) * (1 + cb) + sb
    x = x + gb * _B_ref(h, B_w_gate, B_w_up, B_w_down)
    return x
```

```asm
; @launch kernel=k_prep_kernel grid=(5536,1,1) block=(256,1,1) lds=4096
; @launch kernel=k_ln1_kernel grid=(512,1,1) block=(256,1,1) lds=0
; @launch kernel=k_qproj_kernel grid=(512,1,1) block=(256,1,1) lds=65536
; @launch kernel=k_attn_kernel grid=(256,1,1) block=(512,1,1) lds=65536
; @launch kernel=k_oproj_kernel grid=(256,1,1) block=(256,1,1) lds=65536
; @launch kernel=k_ln2_kernel grid=(512,1,1) block=(256,1,1) lds=0
; @launch kernel=k_ffn1_kernel grid=(448,1,1) block=(256,1,1) lds=65536
; @launch kernel=k_ffn2_kernel grid=(256,1,1) block=(256,1,1) lds=65536
; @launch kernel=k_final_kernel grid=(512,1,1) block=(256,1,1) lds=0
.amdgcn_target "amdgcn-amd-amdhsa--gfx950"
.text
.globl k_prep_kernel
.p2align 8
.type k_prep_kernel,@function
k_prep_kernel:
    s_cmp_lt_u32 s2, 96
    s_cbranch_scc1 B_mod
    s_sub_u32 s2, s2, 96
    s_cmp_lt_u32 s2, 1024
    s_cbranch_scc1 B_k_prepwq_kernel
    s_sub_u32 s2, s2, 1024
    s_cmp_lt_u32 s2, 1024
    s_cbranch_scc1 B_k_prepk_kernel
    s_sub_u32 s2, s2, 1024
    s_cmp_lt_u32 s2, 1024
    s_cbranch_scc1 B_k_prepv_kernel
    s_sub_u32 s2, s2, 1024
    s_cmp_lt_u32 s2, 1024
    s_cbranch_scc1 B_k_prepwo_kernel
    s_sub_u32 s2, s2, 1024
    s_cmp_lt_u32 s2, 448
    s_cbranch_scc1 B_k_prepwg_kernel
    s_sub_u32 s2, s2, 448
    s_cmp_lt_u32 s2, 448
    s_cbranch_scc1 B_k_prepwu_kernel
    s_sub_u32 s2, s2, 448
    s_cmp_lt_u32 s2, 448
    s_cbranch_scc1 B_k_prepwd_kernel
    s_sub_u32 s2, s2, 448
    s_endpgm
B_mod:
    s_load_dwordx2 s[4:5], s[0:1], 72
    s_load_dwordx2 s[6:7], s[0:1], 80
    s_load_dwordx2 s[8:9], s[0:1], 104
    s_waitcnt lgkmcnt(0)
    s_mov_b32 s12, s4
    s_and_b32 s13, s5, 0xffff
    s_mov_b32 s14, 1024
    s_mov_b32 s15, 0x00020000
    s_mov_b32 s16, s6
    s_and_b32 s17, s7, 0xffff
    s_mov_b32 s18, 3145728
    s_mov_b32 s19, 0x00020000
    s_add_u32 s20, s8, 0
    s_addc_u32 s21, s9, 0
    s_and_b32 s21, s21, 0xffff
    s_mov_b32 s22, 12288
    s_mov_b32 s23, 0x00020000
    v_lshlrev_b32 v1, 2, v0
    buffer_load_dword v2, v1, s[12:15], 0 offen
    s_waitcnt vmcnt(0)
    v_lshlrev_b32 v3, 16, v2
    v_and_b32 v4, 0xffff0000, v2
    v_mul_f32 v5, 0xbfb8aa3b, v3
    v_exp_f32 v5, v5
    s_nop 0
    v_add_f32 v5, 1.0, v5
    v_rcp_f32 v5, v5
    s_nop 0
    v_mul_f32 v3, v3, v5
    v_mul_f32 v5, 0xbfb8aa3b, v4
    v_exp_f32 v5, v5
    s_nop 0
    v_add_f32 v5, 1.0, v5
    v_rcp_f32 v5, v5
    s_nop 0
    v_mul_f32 v4, v4, v5
    v_cvt_pk_bf16_f32 v5, v3, v4
    v_lshlrev_b32 v14, 16, v5
    v_and_b32 v15, 0xffff0000, v5
    v_lshlrev_b32 v6, 3, v0
    ds_write_b64 v6, v[14:15]
    s_waitcnt lgkmcnt(0)
    s_barrier
    v_lshrrev_b32 v7, 4, v0
    v_and_b32 v8, 15, v0
    v_lshlrev_b32 v9, 7, v7
    s_lshl_b32 s3, s2, 6
    v_lshlrev_b32 v10, 2, v8
    v_add_u32 v10, s3, v10
    v_mov_b32 v11, 6144
    v_lshlrev_b32 v12, 5, v7
    v_mul_lo_u32 v12, v12, v11
    v_add_u32 v10, v10, v12
    v_mov_b32 v20, 0
    v_mov_b32 v21, 0
    buffer_load_dword v48, v10, s[16:19], 0 offen
    v_add_u32 v10, 6144, v10
    buffer_load_dword v49, v10, s[16:19], 0 offen
    v_add_u32 v10, 6144, v10
    buffer_load_dword v50, v10, s[16:19], 0 offen
    v_add_u32 v10, 6144, v10
    buffer_load_dword v51, v10, s[16:19], 0 offen
    v_add_u32 v10, 6144, v10
    buffer_load_dword v52, v10, s[16:19], 0 offen
    v_add_u32 v10, 6144, v10
    buffer_load_dword v53, v10, s[16:19], 0 offen
    v_add_u32 v10, 6144, v10
    buffer_load_dword v54, v10, s[16:19], 0 offen
    v_add_u32 v10, 6144, v10
    buffer_load_dword v55, v10, s[16:19], 0 offen
    v_add_u32 v10, 6144, v10
    buffer_load_dword v56, v10, s[16:19], 0 offen
    v_add_u32 v10, 6144, v10
    buffer_load_dword v57, v10, s[16:19], 0 offen
    v_add_u32 v10, 6144, v10
    buffer_load_dword v58, v10, s[16:19], 0 offen
    v_add_u32 v10, 6144, v10
    buffer_load_dword v59, v10, s[16:19], 0 offen
    v_add_u32 v10, 6144, v10
    buffer_load_dword v60, v10, s[16:19], 0 offen
    v_add_u32 v10, 6144, v10
    buffer_load_dword v61, v10, s[16:19], 0 offen
    v_add_u32 v10, 6144, v10
    buffer_load_dword v62, v10, s[16:19], 0 offen
    v_add_u32 v10, 6144, v10
    buffer_load_dword v63, v10, s[16:19], 0 offen
    v_add_u32 v10, 6144, v10
    ds_read_b128 v[24:27], v9 offset:0
    ds_read_b128 v[28:31], v9 offset:16
    ds_read_b128 v[32:35], v9 offset:32
    ds_read_b128 v[36:39], v9 offset:48
    s_waitcnt vmcnt(0) lgkmcnt(0)
    v_lshlrev_b32 v40, 16, v48
    v_and_b32 v41, 0xffff0000, v48
    v_fmac_f32 v20, v40, v24
    v_fmac_f32 v21, v41, v24
    v_lshlrev_b32 v40, 16, v49
    v_and_b32 v41, 0xffff0000, v49
    v_fmac_f32 v20, v40, v25
    v_fmac_f32 v21, v41, v25
    v_lshlrev_b32 v40, 16, v50
    v_and_b32 v41, 0xffff0000, v50
    v_fmac_f32 v20, v40, v26
    v_fmac_f32 v21, v41, v26
    v_lshlrev_b32 v40, 16, v51
    v_and_b32 v41, 0xffff0000, v51
    v_fmac_f32 v20, v40, v27
    v_fmac_f32 v21, v41, v27
    v_lshlrev_b32 v40, 16, v52
    v_and_b32 v41, 0xffff0000, v52
    v_fmac_f32 v20, v40, v28
    v_fmac_f32 v21, v41, v28
    v_lshlrev_b32 v40, 16, v53
    v_and_b32 v41, 0xffff0000, v53
    v_fmac_f32 v20, v40, v29
    v_fmac_f32 v21, v41, v29
    v_lshlrev_b32 v40, 16, v54
    v_and_b32 v41, 0xffff0000, v54
    v_fmac_f32 v20, v40, v30
    v_fmac_f32 v21, v41, v30
    v_lshlrev_b32 v40, 16, v55
    v_and_b32 v41, 0xffff0000, v55
    v_fmac_f32 v20, v40, v31
    v_fmac_f32 v21, v41, v31
    v_lshlrev_b32 v40, 16, v56
    v_and_b32 v41, 0xffff0000, v56
    v_fmac_f32 v20, v40, v32
    v_fmac_f32 v21, v41, v32
    v_lshlrev_b32 v40, 16, v57
    v_and_b32 v41, 0xffff0000, v57
    v_fmac_f32 v20, v40, v33
    v_fmac_f32 v21, v41, v33
    v_lshlrev_b32 v40, 16, v58
    v_and_b32 v41, 0xffff0000, v58
    v_fmac_f32 v20, v40, v34
    v_fmac_f32 v21, v41, v34
    v_lshlrev_b32 v40, 16, v59
    v_and_b32 v41, 0xffff0000, v59
    v_fmac_f32 v20, v40, v35
    v_fmac_f32 v21, v41, v35
    v_lshlrev_b32 v40, 16, v60
    v_and_b32 v41, 0xffff0000, v60
    v_fmac_f32 v20, v40, v36
    v_fmac_f32 v21, v41, v36
    v_lshlrev_b32 v40, 16, v61
    v_and_b32 v41, 0xffff0000, v61
    v_fmac_f32 v20, v40, v37
    v_fmac_f32 v21, v41, v37
    v_lshlrev_b32 v40, 16, v62
    v_and_b32 v41, 0xffff0000, v62
    v_fmac_f32 v20, v40, v38
    v_fmac_f32 v21, v41, v38
    v_lshlrev_b32 v40, 16, v63
    v_and_b32 v41, 0xffff0000, v63
    v_fmac_f32 v20, v40, v39
    v_fmac_f32 v21, v41, v39
    buffer_load_dword v48, v10, s[16:19], 0 offen
    v_add_u32 v10, 6144, v10
    buffer_load_dword v49, v10, s[16:19], 0 offen
    v_add_u32 v10, 6144, v10
    buffer_load_dword v50, v10, s[16:19], 0 offen
    v_add_u32 v10, 6144, v10
    buffer_load_dword v51, v10, s[16:19], 0 offen
    v_add_u32 v10, 6144, v10
    buffer_load_dword v52, v10, s[16:19], 0 offen
    v_add_u32 v10, 6144, v10
    buffer_load_dword v53, v10, s[16:19], 0 offen
    v_add_u32 v10, 6144, v10
    buffer_load_dword v54, v10, s[16:19], 0 offen
    v_add_u32 v10, 6144, v10
    buffer_load_dword v55, v10, s[16:19], 0 offen
    v_add_u32 v10, 6144, v10
    buffer_load_dword v56, v10, s[16:19], 0 offen
    v_add_u32 v10, 6144, v10
    buffer_load_dword v57, v10, s[16:19], 0 offen
    v_add_u32 v10, 6144, v10
    buffer_load_dword v58, v10, s[16:19], 0 offen
    v_add_u32 v10, 6144, v10
    buffer_load_dword v59, v10, s[16:19], 0 offen
    v_add_u32 v10, 6144, v10
    buffer_load_dword v60, v10, s[16:19], 0 offen
    v_add_u32 v10, 6144, v10
    buffer_load_dword v61, v10, s[16:19], 0 offen
    v_add_u32 v10, 6144, v10
    buffer_load_dword v62, v10, s[16:19], 0 offen
    v_add_u32 v10, 6144, v10
    buffer_load_dword v63, v10, s[16:19], 0 offen
    v_add_u32 v10, 6144, v10
    ds_read_b128 v[24:27], v9 offset:64
    ds_read_b128 v[28:31], v9 offset:80
    ds_read_b128 v[32:35], v9 offset:96
    ds_read_b128 v[36:39], v9 offset:112
    s_waitcnt vmcnt(0) lgkmcnt(0)
    v_lshlrev_b32 v40, 16, v48
    v_and_b32 v41, 0xffff0000, v48
    v_fmac_f32 v20, v40, v24
    v_fmac_f32 v21, v41, v24
    v_lshlrev_b32 v40, 16, v49
    v_and_b32 v41, 0xffff0000, v49
    v_fmac_f32 v20, v40, v25
    v_fmac_f32 v21, v41, v25
    v_lshlrev_b32 v40, 16, v50
    v_and_b32 v41, 0xffff0000, v50
    v_fmac_f32 v20, v40, v26
    v_fmac_f32 v21, v41, v26
    v_lshlrev_b32 v40, 16, v51
    v_and_b32 v41, 0xffff0000, v51
    v_fmac_f32 v20, v40, v27
    v_fmac_f32 v21, v41, v27
    v_lshlrev_b32 v40, 16, v52
    v_and_b32 v41, 0xffff0000, v52
    v_fmac_f32 v20, v40, v28
    v_fmac_f32 v21, v41, v28
    v_lshlrev_b32 v40, 16, v53
    v_and_b32 v41, 0xffff0000, v53
    v_fmac_f32 v20, v40, v29
    v_fmac_f32 v21, v41, v29
    v_lshlrev_b32 v40, 16, v54
    v_and_b32 v41, 0xffff0000, v54
    v_fmac_f32 v20, v40, v30
    v_fmac_f32 v21, v41, v30
    v_lshlrev_b32 v40, 16, v55
    v_and_b32 v41, 0xffff0000, v55
    v_fmac_f32 v20, v40, v31
    v_fmac_f32 v21, v41, v31
    v_lshlrev_b32 v40, 16, v56
    v_and_b32 v41, 0xffff0000, v56
    v_fmac_f32 v20, v40, v32
    v_fmac_f32 v21, v41, v32
    v_lshlrev_b32 v40, 16, v57
    v_and_b32 v41, 0xffff0000, v57
    v_fmac_f32 v20, v40, v33
    v_fmac_f32 v21, v41, v33
    v_lshlrev_b32 v40, 16, v58
    v_and_b32 v41, 0xffff0000, v58
    v_fmac_f32 v20, v40, v34
    v_fmac_f32 v21, v41, v34
    v_lshlrev_b32 v40, 16, v59
    v_and_b32 v41, 0xffff0000, v59
    v_fmac_f32 v20, v40, v35
    v_fmac_f32 v21, v41, v35
    v_lshlrev_b32 v40, 16, v60
    v_and_b32 v41, 0xffff0000, v60
    v_fmac_f32 v20, v40, v36
    v_fmac_f32 v21, v41, v36
    v_lshlrev_b32 v40, 16, v61
    v_and_b32 v41, 0xffff0000, v61
    v_fmac_f32 v20, v40, v37
    v_fmac_f32 v21, v41, v37
    v_lshlrev_b32 v40, 16, v62
    v_and_b32 v41, 0xffff0000, v62
    v_fmac_f32 v20, v40, v38
    v_fmac_f32 v21, v41, v38
    v_lshlrev_b32 v40, 16, v63
    v_and_b32 v41, 0xffff0000, v63
    v_fmac_f32 v20, v40, v39
    v_fmac_f32 v21, v41, v39
    v_lshlrev_b32 v9, 3, v0
    v_add_u32 v9, 2048, v9
    ds_write_b64 v9, v[20:21]
    s_waitcnt lgkmcnt(0)
    s_barrier
    v_lshlrev_b32 v9, 3, v8
    v_add_u32 v9, 2048, v9
    ds_read_b64 v[24:25], v9 offset:0
    ds_read_b64 v[26:27], v9 offset:128
    ds_read_b64 v[28:29], v9 offset:256
    ds_read_b64 v[30:31], v9 offset:384
    ds_read_b64 v[32:33], v9 offset:512
    ds_read_b64 v[34:35], v9 offset:640
    ds_read_b64 v[36:37], v9 offset:768
    ds_read_b64 v[38:39], v9 offset:896
    ds_read_b64 v[40:41], v9 offset:1024
    ds_read_b64 v[42:43], v9 offset:1152
    ds_read_b64 v[44:45], v9 offset:1280
    ds_read_b64 v[46:47], v9 offset:1408
    ds_read_b64 v[48:49], v9 offset:1536
    ds_read_b64 v[50:51], v9 offset:1664
    ds_read_b64 v[52:53], v9 offset:1792
    ds_read_b64 v[54:55], v9 offset:1920
    s_waitcnt lgkmcnt(0)
    v_add_f32 v24, v24, v26
    v_add_f32 v25, v25, v27
    v_add_f32 v24, v24, v28
    v_add_f32 v25, v25, v29
    v_add_f32 v24, v24, v30
    v_add_f32 v25, v25, v31
    v_add_f32 v24, v24, v32
    v_add_f32 v25, v25, v33
    v_add_f32 v24, v24, v34
    v_add_f32 v25, v25, v35
    v_add_f32 v24, v24, v36
    v_add_f32 v25, v25, v37
    v_add_f32 v24, v24, v38
    v_add_f32 v25, v25, v39
    v_add_f32 v24, v24, v40
    v_add_f32 v25, v25, v41
    v_add_f32 v24, v24, v42
    v_add_f32 v25, v25, v43
    v_add_f32 v24, v24, v44
    v_add_f32 v25, v25, v45
    v_add_f32 v24, v24, v46
    v_add_f32 v25, v25, v47
    v_add_f32 v24, v24, v48
    v_add_f32 v25, v25, v49
    v_add_f32 v24, v24, v50
    v_add_f32 v25, v25, v51
    v_add_f32 v24, v24, v52
    v_add_f32 v25, v25, v53
    v_add_f32 v24, v24, v54
    v_add_f32 v25, v25, v55
    v_cvt_pk_bf16_f32 v26, v24, v25
    v_lshlrev_b32 v24, 16, v26
    v_and_b32 v25, 0xffff0000, v26
    s_lshl_b32 s3, s2, 7
    v_lshlrev_b32 v9, 3, v8
    v_add_u32 v9, s3, v9
    v_cmp_gt_u32 vcc, 16, v0
    s_and_saveexec_b64 s[24:25], vcc
    buffer_store_dwordx2 v[24:25], v9, s[20:23], 0 offen
    s_waitcnt vmcnt(0)
    s_endpgm
B_k_prepk_kernel:
    s_load_dwordx2 s[4:5], s[0:1], 8
    s_load_dwordx2 s[8:9], s[0:1], 104
    s_waitcnt lgkmcnt(0)
    s_mov_b32 s12, s4
    s_and_b32 s13, s5, 0xffff
    s_mov_b32 s14, 4194304
    s_mov_b32 s15, 0x00020000
    s_add_u32 s16, s8, 1048576
    s_addc_u32 s17, s9, 0
    s_and_b32 s17, s17, 0xffff
    s_mov_b32 s18, 4194304
    s_mov_b32 s19, 0x00020000
    v_lshrrev_b32 v1, 6, v0
    s_lshl_b32 s3, s2, 2
    v_add_u32 v1, s3, v1
    v_and_b32 v2, 63, v0
    v_lshrrev_b32 v3, 3, v1
    v_and_b32 v4, 7, v1
    v_and_b32 v5, 31, v2
    v_lshl_add_u32 v5, v3, 5, v5
    v_lshlrev_b32 v5, 8, v5
    v_lshl_add_u32 v5, v4, 5, v5
    v_lshrrev_b32 v6, 5, v2
    v_lshl_add_u32 v5, v6, 4, v5
    buffer_load_dwordx4 v[8:11], v5, s[12:15], 0 offen
    v_lshlrev_b32 v7, 10, v1
    v_lshl_add_u32 v7, v2, 4, v7
    s_waitcnt vmcnt(0)
    buffer_store_dwordx4 v[8:11], v7, s[16:19], 0 offen
    s_waitcnt vmcnt(0)
    s_endpgm
B_k_prepv_kernel:
    s_load_dwordx2 s[4:5], s[0:1], 16
    s_load_dwordx2 s[8:9], s[0:1], 104
    s_waitcnt lgkmcnt(0)
    s_mov_b32 s12, s4
    s_and_b32 s13, s5, 0xffff
    s_mov_b32 s14, 4194304
    s_mov_b32 s15, 0x00020000
    s_add_u32 s16, s8, 5242880
    s_addc_u32 s17, s9, 0
    s_and_b32 s17, s17, 0xffff
    s_mov_b32 s18, 4194304
    s_mov_b32 s19, 0x00020000
    v_lshrrev_b32 v1, 6, v0
    s_lshl_b32 s3, s2, 2
    v_add_u32 v1, s3, v1
    v_and_b32 v2, 63, v0
    v_lshrrev_b32 v3, 2, v1
    v_and_b32 v4, 3, v1
    v_lshrrev_b32 v6, 5, v2
    v_lshlrev_b32 v6, 2, v6
    v_lshl_add_u32 v5, v3, 4, v6
    v_lshlrev_b32 v5, 8, v5
    v_and_b32 v6, 31, v2
    v_lshl_add_u32 v6, v4, 5, v6
    v_lshl_add_u32 v5, v6, 1, v5
    buffer_load_ushort v16, v5, s[12:15], 0 offen offset:0
    buffer_load_ushort v17, v5, s[12:15], 0 offen offset:256
    buffer_load_ushort v18, v5, s[12:15], 0 offen offset:512
    buffer_load_ushort v19, v5, s[12:15], 0 offen offset:768
    buffer_load_ushort v20, v5, s[12:15], 0 offen offset:2048
    buffer_load_ushort v21, v5, s[12:15], 0 offen offset:2304
    buffer_load_ushort v22, v5, s[12:15], 0 offen offset:2560
    buffer_load_ushort v23, v5, s[12:15], 0 offen offset:2816
    v_lshlrev_b32 v7, 10, v1
    v_lshl_add_u32 v7, v2, 4, v7
    s_waitcnt vmcnt(0)
    v_lshl_or_b32 v8, v17, 16, v16
    v_lshl_or_b32 v9, v19, 16, v18
    v_lshl_or_b32 v10, v21, 16, v20
    v_lshl_or_b32 v11, v23, 16, v22
    buffer_store_dwordx4 v[8:11], v7, s[16:19], 0 offen
    s_waitcnt vmcnt(0)
    s_endpgm
B_k_prepwq_kernel:
    s_load_dwordx2 s[4:5], s[0:1], 24
    s_load_dwordx2 s[8:9], s[0:1], 104
    s_waitcnt lgkmcnt(0)
    s_mov_b32 s12, s4
    s_and_b32 s13, s5, 0xffff
    s_mov_b32 s14, 4194304
    s_mov_b32 s15, 0x00020000
    s_add_u32 s16, s8, 9437184
    s_addc_u32 s17, s9, 0
    s_and_b32 s17, s17, 0xffff
    s_mov_b32 s18, 4194304
    s_mov_b32 s19, 0x00020000
    v_lshrrev_b32 v1, 6, v0
    s_lshl_b32 s3, s2, 2
    v_add_u32 v1, s3, v1
    v_and_b32 v2, 63, v0
    s_mov_b32 s20, 134217728
    v_mul_hi_u32 v3, v1, s20
    s_mov_b32 s21, 32
    v_mul_lo_u32 v4, v3, s21
    v_sub_u32 v4, v1, v4
    v_lshrrev_b32 v5, 5, v2
    v_lshlrev_b32 v5, 3, v5
    v_lshl_add_u32 v5, v4, 4, v5
    s_mov_b32 s21, 8192
    v_mul_lo_u32 v5, v5, s21
    v_and_b32 v6, 31, v2
    v_lshl_add_u32 v6, v3, 5, v6
    v_lshl_add_u32 v5, v6, 1, v5
    buffer_load_ushort v16, v5, s[12:15], 0 offen
    v_add_u32 v5, s21, v5
    buffer_load_ushort v17, v5, s[12:15], 0 offen
    v_add_u32 v5, s21, v5
    buffer_load_ushort v18, v5, s[12:15], 0 offen
    v_add_u32 v5, s21, v5
    buffer_load_ushort v19, v5, s[12:15], 0 offen
    v_add_u32 v5, s21, v5
    buffer_load_ushort v20, v5, s[12:15], 0 offen
    v_add_u32 v5, s21, v5
    buffer_load_ushort v21, v5, s[12:15], 0 offen
    v_add_u32 v5, s21, v5
    buffer_load_ushort v22, v5, s[12:15], 0 offen
    v_add_u32 v5, s21, v5
    buffer_load_ushort v23, v5, s[12:15], 0 offen
    v_add_u32 v5, s21, v5
    v_lshlrev_b32 v7, 10, v1
    v_lshl_add_u32 v7, v2, 4, v7
    s_waitcnt vmcnt(0)
    v_lshl_or_b32 v8, v17, 16, v16
    v_lshl_or_b32 v9, v19, 16, v18
    v_lshl_or_b32 v10, v21, 16, v20
    v_lshl_or_b32 v11, v23, 16, v22
    buffer_store_dwordx4 v[8:11], v7, s[16:19], 0 offen
    s_waitcnt vmcnt(0)
    s_endpgm
B_k_prepwo_kernel:
    s_load_dwordx2 s[4:5], s[0:1], 32
    s_load_dwordx2 s[8:9], s[0:1], 104
    s_waitcnt lgkmcnt(0)
    s_mov_b32 s12, s4
    s_and_b32 s13, s5, 0xffff
    s_mov_b32 s14, 4194304
    s_mov_b32 s15, 0x00020000
    s_add_u32 s16, s8, 13631488
    s_addc_u32 s17, s9, 0
    s_and_b32 s17, s17, 0xffff
    s_mov_b32 s18, 4194304
    s_mov_b32 s19, 0x00020000
    v_lshrrev_b32 v1, 6, v0
    s_lshl_b32 s3, s2, 2
    v_add_u32 v1, s3, v1
    v_and_b32 v2, 63, v0
    s_mov_b32 s20, 16777216
    v_mul_hi_u32 v3, v1, s20
    s_mov_b32 s21, 256
    v_mul_lo_u32 v4, v3, s21
    v_sub_u32 v4, v1, v4
    v_lshrrev_b32 v5, 5, v2
    v_lshlrev_b32 v5, 3, v5
    v_lshl_add_u32 v5, v4, 4, v5
    s_mov_b32 s21, 1024
    v_mul_lo_u32 v5, v5, s21
    v_and_b32 v6, 31, v2
    v_lshl_add_u32 v6, v3, 5, v6
    v_lshl_add_u32 v5, v6, 1, v5
    buffer_load_ushort v16, v5, s[12:15], 0 offen
    v_add_u32 v5, s21, v5
    buffer_load_ushort v17, v5, s[12:15], 0 offen
    v_add_u32 v5, s21, v5
    buffer_load_ushort v18, v5, s[12:15], 0 offen
    v_add_u32 v5, s21, v5
    buffer_load_ushort v19, v5, s[12:15], 0 offen
    v_add_u32 v5, s21, v5
    buffer_load_ushort v20, v5, s[12:15], 0 offen
    v_add_u32 v5, s21, v5
    buffer_load_ushort v21, v5, s[12:15], 0 offen
    v_add_u32 v5, s21, v5
    buffer_load_ushort v22, v5, s[12:15], 0 offen
    v_add_u32 v5, s21, v5
    buffer_load_ushort v23, v5, s[12:15], 0 offen
    v_add_u32 v5, s21, v5
    v_lshlrev_b32 v7, 10, v1
    v_lshl_add_u32 v7, v2, 4, v7
    s_waitcnt vmcnt(0)
    v_lshl_or_b32 v8, v17, 16, v16
    v_lshl_or_b32 v9, v19, 16, v18
    v_lshl_or_b32 v10, v21, 16, v20
    v_lshl_or_b32 v11, v23, 16, v22
    buffer_store_dwordx4 v[8:11], v7, s[16:19], 0 offen
    s_waitcnt vmcnt(0)
    s_endpgm
B_k_prepwg_kernel:
    s_load_dwordx2 s[4:5], s[0:1], 48
    s_load_dwordx2 s[8:9], s[0:1], 104
    s_waitcnt lgkmcnt(0)
    s_mov_b32 s12, s4
    s_and_b32 s13, s5, 0xffff
    s_mov_b32 s14, 1835008
    s_mov_b32 s15, 0x00020000
    s_add_u32 s16, s8, 17825792
    s_addc_u32 s17, s9, 0
    s_and_b32 s17, s17, 0xffff
    s_mov_b32 s18, 1835008
    s_mov_b32 s19, 0x00020000
    v_lshrrev_b32 v1, 6, v0
    s_lshl_b32 s3, s2, 2
    v_add_u32 v1, s3, v1
    v_and_b32 v2, 63, v0
    s_mov_b32 s20, 134217728
    v_mul_hi_u32 v3, v1, s20
    s_mov_b32 s21, 32
    v_mul_lo_u32 v4, v3, s21
    v_sub_u32 v4, v1, v4
    v_lshrrev_b32 v5, 5, v2
    v_lshlrev_b32 v5, 3, v5
    v_lshl_add_u32 v5, v4, 4, v5
    s_mov_b32 s21, 3584
    v_mul_lo_u32 v5, v5, s21
    v_and_b32 v6, 31, v2
    v_lshl_add_u32 v6, v3, 5, v6
    v_lshl_add_u32 v5, v6, 1, v5
    buffer_load_ushort v16, v5, s[12:15], 0 offen
    v_add_u32 v5, s21, v5
    buffer_load_ushort v17, v5, s[12:15], 0 offen
    v_add_u32 v5, s21, v5
    buffer_load_ushort v18, v5, s[12:15], 0 offen
    v_add_u32 v5, s21, v5
    buffer_load_ushort v19, v5, s[12:15], 0 offen
    v_add_u32 v5, s21, v5
    buffer_load_ushort v20, v5, s[12:15], 0 offen
    v_add_u32 v5, s21, v5
    buffer_load_ushort v21, v5, s[12:15], 0 offen
    v_add_u32 v5, s21, v5
    buffer_load_ushort v22, v5, s[12:15], 0 offen
    v_add_u32 v5, s21, v5
    buffer_load_ushort v23, v5, s[12:15], 0 offen
    v_add_u32 v5, s21, v5
    v_lshlrev_b32 v7, 10, v1
    v_lshl_add_u32 v7, v2, 4, v7
    s_waitcnt vmcnt(0)
    v_lshl_or_b32 v8, v17, 16, v16
    v_lshl_or_b32 v9, v19, 16, v18
    v_lshl_or_b32 v10, v21, 16, v20
    v_lshl_or_b32 v11, v23, 16, v22
    buffer_store_dwordx4 v[8:11], v7, s[16:19], 0 offen
    s_waitcnt vmcnt(0)
    s_endpgm
B_k_prepwu_kernel:
    s_load_dwordx2 s[4:5], s[0:1], 56
    s_load_dwordx2 s[8:9], s[0:1], 104
    s_waitcnt lgkmcnt(0)
    s_mov_b32 s12, s4
    s_and_b32 s13, s5, 0xffff
    s_mov_b32 s14, 1835008
    s_mov_b32 s15, 0x00020000
    s_add_u32 s16, s8, 19922944
    s_addc_u32 s17, s9, 0
    s_and_b32 s17, s17, 0xffff
    s_mov_b32 s18, 1835008
    s_mov_b32 s19, 0x00020000
    v_lshrrev_b32 v1, 6, v0
    s_lshl_b32 s3, s2, 2
    v_add_u32 v1, s3, v1
    v_and_b32 v2, 63, v0
    s_mov_b32 s20, 134217728
    v_mul_hi_u32 v3, v1, s20
    s_mov_b32 s21, 32
    v_mul_lo_u32 v4, v3, s21
    v_sub_u32 v4, v1, v4
    v_lshrrev_b32 v5, 5, v2
    v_lshlrev_b32 v5, 3, v5
    v_lshl_add_u32 v5, v4, 4, v5
    s_mov_b32 s21, 3584
    v_mul_lo_u32 v5, v5, s21
    v_and_b32 v6, 31, v2
    v_lshl_add_u32 v6, v3, 5, v6
    v_lshl_add_u32 v5, v6, 1, v5
    buffer_load_ushort v16, v5, s[12:15], 0 offen
    v_add_u32 v5, s21, v5
    buffer_load_ushort v17, v5, s[12:15], 0 offen
    v_add_u32 v5, s21, v5
    buffer_load_ushort v18, v5, s[12:15], 0 offen
    v_add_u32 v5, s21, v5
    buffer_load_ushort v19, v5, s[12:15], 0 offen
    v_add_u32 v5, s21, v5
    buffer_load_ushort v20, v5, s[12:15], 0 offen
    v_add_u32 v5, s21, v5
    buffer_load_ushort v21, v5, s[12:15], 0 offen
    v_add_u32 v5, s21, v5
    buffer_load_ushort v22, v5, s[12:15], 0 offen
    v_add_u32 v5, s21, v5
    buffer_load_ushort v23, v5, s[12:15], 0 offen
    v_add_u32 v5, s21, v5
    v_lshlrev_b32 v7, 10, v1
    v_lshl_add_u32 v7, v2, 4, v7
    s_waitcnt vmcnt(0)
    v_lshl_or_b32 v8, v17, 16, v16
    v_lshl_or_b32 v9, v19, 16, v18
    v_lshl_or_b32 v10, v21, 16, v20
    v_lshl_or_b32 v11, v23, 16, v22
    buffer_store_dwordx4 v[8:11], v7, s[16:19], 0 offen
    s_waitcnt vmcnt(0)
    s_endpgm
B_k_prepwd_kernel:
    s_load_dwordx2 s[4:5], s[0:1], 64
    s_load_dwordx2 s[8:9], s[0:1], 104
    s_waitcnt lgkmcnt(0)
    s_mov_b32 s12, s4
    s_and_b32 s13, s5, 0xffff
    s_mov_b32 s14, 1835008
    s_mov_b32 s15, 0x00020000
    s_add_u32 s16, s8, 22020096
    s_addc_u32 s17, s9, 0
    s_and_b32 s17, s17, 0xffff
    s_mov_b32 s18, 1835008
    s_mov_b32 s19, 0x00020000
    v_lshrrev_b32 v1, 6, v0
    s_lshl_b32 s3, s2, 2
    v_add_u32 v1, s3, v1
    v_and_b32 v2, 63, v0
    s_mov_b32 s20, 38347923
    v_mul_hi_u32 v3, v1, s20
    s_mov_b32 s21, 112
    v_mul_lo_u32 v4, v3, s21
    v_sub_u32 v4, v1, v4
    v_lshrrev_b32 v5, 5, v2
    v_lshlrev_b32 v5, 3, v5
    v_lshl_add_u32 v5, v4, 4, v5
    s_mov_b32 s21, 1024
    v_mul_lo_u32 v5, v5, s21
    v_and_b32 v6, 31, v2
    v_lshl_add_u32 v6, v3, 5, v6
    v_lshl_add_u32 v5, v6, 1, v5
    buffer_load_ushort v16, v5, s[12:15], 0 offen
    v_add_u32 v5, s21, v5
    buffer_load_ushort v17, v5, s[12:15], 0 offen
    v_add_u32 v5, s21, v5
    buffer_load_ushort v18, v5, s[12:15], 0 offen
    v_add_u32 v5, s21, v5
    buffer_load_ushort v19, v5, s[12:15], 0 offen
    v_add_u32 v5, s21, v5
    buffer_load_ushort v20, v5, s[12:15], 0 offen
    v_add_u32 v5, s21, v5
    buffer_load_ushort v21, v5, s[12:15], 0 offen
    v_add_u32 v5, s21, v5
    buffer_load_ushort v22, v5, s[12:15], 0 offen
    v_add_u32 v5, s21, v5
    buffer_load_ushort v23, v5, s[12:15], 0 offen
    v_add_u32 v5, s21, v5
    v_lshlrev_b32 v7, 10, v1
    v_lshl_add_u32 v7, v2, 4, v7
    s_waitcnt vmcnt(0)
    v_lshl_or_b32 v8, v17, 16, v16
    v_lshl_or_b32 v9, v19, 16, v18
    v_lshl_or_b32 v10, v21, 16, v20
    v_lshl_or_b32 v11, v23, 16, v22
    buffer_store_dwordx4 v[8:11], v7, s[16:19], 0 offen
    s_waitcnt vmcnt(0)
    s_endpgm
    s_endpgm
.globl k_ln1_kernel
.p2align 8
.type k_ln1_kernel,@function
k_ln1_kernel:
    s_cmp_ge_u32 s2, 512
    s_cbranch_scc1 L_k_ln1_kernel_done
    s_load_dwordx2 s[4:5], s[0:1], 0
    s_load_dwordx2 s[8:9], s[0:1], 104
    s_waitcnt lgkmcnt(0)
    s_mov_b32 s12, s4
    s_and_b32 s13, s5, 0xffff
    s_mov_b32 s14, 2097152
    s_mov_b32 s15, 0x00020000
    s_add_u32 s16, s8, 0
    s_addc_u32 s17, s9, 0
    s_and_b32 s17, s17, 0xffff
    s_mov_b32 s18, 12288
    s_mov_b32 s19, 0x00020000
    s_add_u32 s20, s8, 24117248
    s_addc_u32 s21, s9, 0
    s_and_b32 s21, s21, 0xffff
    s_mov_b32 s22, 2097152
    s_mov_b32 s23, 0x00020000
    v_lshrrev_b32 v1, 6, v0
    s_lshl_b32 s3, s2, 2
    v_add_u32 v1, s3, v1
    v_and_b32 v2, 63, v0
    v_lshlrev_b32 v3, 10, v1
    v_lshl_add_u32 v3, v2, 4, v3
    buffer_load_dwordx4 v[8:11], v3, s[12:15], 0 offen
    v_lshlrev_b32 v4, 5, v2
    v_add_u32 v5, 0, v4
    buffer_load_dwordx4 v[12:15], v5, s[16:19], 0 offen
    buffer_load_dwordx4 v[16:19], v5, s[16:19], 0 offen offset:16
    v_add_u32 v5, 2048, v4
    buffer_load_dwordx4 v[20:23], v5, s[16:19], 0 offen
    buffer_load_dwordx4 v[24:27], v5, s[16:19], 0 offen offset:16
    s_waitcnt vmcnt(0)
    v_lshlrev_b32 v40, 16, v8
    v_and_b32 v41, 0xffff0000, v8
    v_lshlrev_b32 v42, 16, v9
    v_and_b32 v43, 0xffff0000, v9
    v_lshlrev_b32 v44, 16, v10
    v_and_b32 v45, 0xffff0000, v10
    v_lshlrev_b32 v46, 16, v11
    v_and_b32 v47, 0xffff0000, v11
    v_add_f32 v36, v40, v41
    v_add_f32 v36, v36, v42
    v_add_f32 v36, v36, v43
    v_add_f32 v36, v36, v44
    v_add_f32 v36, v36, v45
    v_add_f32 v36, v36, v46
    v_add_f32 v36, v36, v47
    ds_swizzle_b32 v37, v36 offset:1055
    s_waitcnt lgkmcnt(0)
    v_add_f32 v36, v36, v37
    ds_swizzle_b32 v37, v36 offset:2079
    s_waitcnt lgkmcnt(0)
    v_add_f32 v36, v36, v37
    ds_swizzle_b32 v37, v36 offset:4127
    s_waitcnt lgkmcnt(0)
    v_add_f32 v36, v36, v37
    ds_swizzle_b32 v37, v36 offset:8223
    s_waitcnt lgkmcnt(0)
    v_add_f32 v36, v36, v37
    ds_swizzle_b32 v37, v36 offset:16415
    s_waitcnt lgkmcnt(0)
    v_add_f32 v36, v36, v37
    v_mov_b32 v37, v36
    s_nop 1
    v_permlane32_swap_b32 v36, v37
    v_add_f32 v36, v36, v37
    v_mul_f32 v36, 0x3b000000, v36
    v_sub_f32 v40, v40, v36
    v_sub_f32 v41, v41, v36
    v_sub_f32 v42, v42, v36
    v_sub_f32 v43, v43, v36
    v_sub_f32 v44, v44, v36
    v_sub_f32 v45, v45, v36
    v_sub_f32 v46, v46, v36
    v_sub_f32 v47, v47, v36
    v_mul_f32 v38, v40, v40
    v_fmac_f32 v38, v41, v41
    v_fmac_f32 v38, v42, v42
    v_fmac_f32 v38, v43, v43
    v_fmac_f32 v38, v44, v44
    v_fmac_f32 v38, v45, v45
    v_fmac_f32 v38, v46, v46
    v_fmac_f32 v38, v47, v47
    ds_swizzle_b32 v37, v38 offset:1055
    s_waitcnt lgkmcnt(0)
    v_add_f32 v38, v38, v37
    ds_swizzle_b32 v37, v38 offset:2079
    s_waitcnt lgkmcnt(0)
    v_add_f32 v38, v38, v37
    ds_swizzle_b32 v37, v38 offset:4127
    s_waitcnt lgkmcnt(0)
    v_add_f32 v38, v38, v37
    ds_swizzle_b32 v37, v38 offset:8223
    s_waitcnt lgkmcnt(0)
    v_add_f32 v38, v38, v37
    ds_swizzle_b32 v37, v38 offset:16415
    s_waitcnt lgkmcnt(0)
    v_add_f32 v38, v38, v37
    v_mov_b32 v37, v38
    s_nop 1
    v_permlane32_swap_b32 v38, v37
    v_add_f32 v38, v38, v37
    v_mov_b32 v39, 0x3727c5ac
    v_fmac_f32 v39, 0x3b000000, v38
    v_rsq_f32 v39, v39
    s_nop 0
    v_mul_f32 v40, v40, v39
    v_add_f32 v20, 1.0, v20
    v_fma_f32 v40, v40, v20, v12
    v_mul_f32 v41, v41, v39
    v_add_f32 v21, 1.0, v21
    v_fma_f32 v41, v41, v21, v13
    v_mul_f32 v42, v42, v39
    v_add_f32 v22, 1.0, v22
    v_fma_f32 v42, v42, v22, v14
    v_mul_f32 v43, v43, v39
    v_add_f32 v23, 1.0, v23
    v_fma_f32 v43, v43, v23, v15
    v_mul_f32 v44, v44, v39
    v_add_f32 v24, 1.0, v24
    v_fma_f32 v44, v44, v24, v16
    v_mul_f32 v45, v45, v39
    v_add_f32 v25, 1.0, v25
    v_fma_f32 v45, v45, v25, v17
    v_mul_f32 v46, v46, v39
    v_add_f32 v26, 1.0, v26
    v_fma_f32 v46, v46, v26, v18
    v_mul_f32 v47, v47, v39
    v_add_f32 v27, 1.0, v27
    v_fma_f32 v47, v47, v27, v19
    v_cvt_pk_bf16_f32 v8, v40, v41
    v_cvt_pk_bf16_f32 v9, v42, v43
    v_cvt_pk_bf16_f32 v10, v44, v45
    v_cvt_pk_bf16_f32 v11, v46, v47
    v_lshrrev_b32 v3, 5, v1
    v_lshlrev_b32 v3, 5, v3
    v_lshrrev_b32 v4, 1, v2
    v_add_u32 v3, v3, v4
    v_lshlrev_b32 v3, 6, v3
    v_and_b32 v4, 31, v1
    v_add_u32 v3, v3, v4
    v_and_b32 v4, 1, v2
    v_lshl_add_u32 v3, v4, 5, v3
    v_lshlrev_b32 v3, 4, v3
    buffer_store_dwordx4 v[8:11], v3, s[20:23], 0 offen
    s_waitcnt vmcnt(0)
L_k_ln1_kernel_done:
    s_endpgm
.globl k_qproj_kernel
.p2align 8
.type k_qproj_kernel,@function
k_qproj_kernel:
    s_cmp_ge_u32 s2, 512
    s_cbranch_scc1 L_k_qproj_kernel_done
    s_load_dwordx2 s[8:9], s[0:1], 104
    s_waitcnt lgkmcnt(0)
    s_add_u32 s12, s8, 9437184
    s_addc_u32 s13, s9, 0
    s_and_b32 s13, s13, 0xffff
    s_mov_b32 s14, 4194304
    s_mov_b32 s15, 0x00020000
    s_add_u32 s20, s8, 24117248
    s_addc_u32 s21, s9, 0
    s_and_b32 s21, s21, 0xffff
    s_mov_b32 s22, 2097152
    s_mov_b32 s23, 0x00020000
    s_add_u32 s24, s8, 26214400
    s_addc_u32 s25, s9, 0
    s_and_b32 s25, s25, 0xffff
    s_mov_b32 s26, 16777216
    s_mov_b32 s27, 0x00020000
    s_and_b32 s28, s2, 15
    s_lshr_b32 s29, s2, 4
    s_mul_hi_u32 s30, s29, 134217728
    s_mul_i32 s31, s30, 32
    s_sub_u32 s29, s29, s31
    v_lshrrev_b32 v1, 6, v0
    v_and_b32 v2, 63, v0
    s_nop 0
    v_readfirstlane_b32 s32, v1
    s_lshl_b32 s33, s29, 2
    s_add_u32 s33, s33, s32
    s_mul_i32 s33, s33, 32768
    s_mul_i32 s34, s30, 32768
    s_add_u32 s33, s33, s34
    s_lshl_b32 s35, s28, 2
    s_add_u32 s35, s35, s32
    s_mul_i32 s35, s35, 32768
    s_add_u32 s35, s35, s34
    v_lshlrev_b32 v3, 4, v2
    v_add_u32 v4, s33, v3
    v_add_u32 v5, s35, v3
    s_lshl_b32 s36, s32, 12
    v_mov_b32 v64, 0
    v_mov_b32 v65, 0
    v_mov_b32 v66, 0
    v_mov_b32 v67, 0
    v_mov_b32 v68, 0
    v_mov_b32 v69, 0
    v_mov_b32 v70, 0
    v_mov_b32 v71, 0
    v_mov_b32 v72, 0
    v_mov_b32 v73, 0
    v_mov_b32 v74, 0
    v_mov_b32 v75, 0
    v_mov_b32 v76, 0
    v_mov_b32 v77, 0
    v_mov_b32 v78, 0
    v_mov_b32 v79, 0
    v_mov_b32 v80, 0
    v_mov_b32 v81, 0
    v_mov_b32 v82, 0
    v_mov_b32 v83, 0
    v_mov_b32 v84, 0
    v_mov_b32 v85, 0
    v_mov_b32 v86, 0
    v_mov_b32 v87, 0
    v_mov_b32 v88, 0
    v_mov_b32 v89, 0
    v_mov_b32 v90, 0
    v_mov_b32 v91, 0
    v_mov_b32 v92, 0
    v_mov_b32 v93, 0
    v_mov_b32 v94, 0
    v_mov_b32 v95, 0
    v_mov_b32 v96, 0
    v_mov_b32 v97, 0
    v_mov_b32 v98, 0
    v_mov_b32 v99, 0
    v_mov_b32 v100, 0
    v_mov_b32 v101, 0
    v_mov_b32 v102, 0
    v_mov_b32 v103, 0
    v_mov_b32 v104, 0
    v_mov_b32 v105, 0
    v_mov_b32 v106, 0
    v_mov_b32 v107, 0
    v_mov_b32 v108, 0
    v_mov_b32 v109, 0
    v_mov_b32 v110, 0
    v_mov_b32 v111, 0
    v_mov_b32 v112, 0
    v_mov_b32 v113, 0
    v_mov_b32 v114, 0
    v_mov_b32 v115, 0
    v_mov_b32 v116, 0
    v_mov_b32 v117, 0
    v_mov_b32 v118, 0
    v_mov_b32 v119, 0
    v_mov_b32 v120, 0
    v_mov_b32 v121, 0
    v_mov_b32 v122, 0
    v_mov_b32 v123, 0
    v_mov_b32 v124, 0
    v_mov_b32 v125, 0
    v_mov_b32 v126, 0
    v_mov_b32 v127, 0
    v_and_b32 v6, 1, v1
    v_lshlrev_b32 v6, 13, v6
    v_add_u32 v6, v6, v3
    v_lshrrev_b32 v7, 1, v1
    v_lshlrev_b32 v7, 13, v7
    v_add_u32 v7, v7, v3
    v_add_u32 v7, 16384, v7
    s_mov_b32 s40, 0
    s_mov_b32 s42, 0
    s_add_u32 m0, s40, s36
    s_nop 0
    buffer_load_dwordx4 v4, s[12:15], s42 offen offset:0 lds
    buffer_load_dwordx4 v4, s[12:15], s42 offen offset:1024 lds
    buffer_load_dwordx4 v4, s[12:15], s42 offen offset:2048 lds
    buffer_load_dwordx4 v4, s[12:15], s42 offen offset:3072 lds
    s_add_u32 s41, s40, 16384
    s_add_u32 m0, s41, s36
    s_nop 0
    buffer_load_dwordx4 v5, s[20:23], s42 offen offset:0 lds
    buffer_load_dwordx4 v5, s[20:23], s42 offen offset:1024 lds
    buffer_load_dwordx4 v5, s[20:23], s42 offen offset:2048 lds
    buffer_load_dwordx4 v5, s[20:23], s42 offen offset:3072 lds
    s_mov_b32 s43, 0
L_k_qproj_kernel_loop:
    s_waitcnt vmcnt(0)
    s_barrier
    s_add_u32 s44, s43, 1
    s_cmp_lt_u32 s44, 8
    s_cbranch_scc0 L_k_qproj_kernel_nodma
    s_xor_b32 s40, s40, 32768
    s_add_u32 s42, s42, 4096
    s_add_u32 m0, s40, s36
    s_nop 0
    buffer_load_dwordx4 v4, s[12:15], s42 offen offset:0 lds
    buffer_load_dwordx4 v4, s[12:15], s42 offen offset:1024 lds
    buffer_load_dwordx4 v4, s[12:15], s42 offen offset:2048 lds
    buffer_load_dwordx4 v4, s[12:15], s42 offen offset:3072 lds
    s_add_u32 s41, s40, 16384
    s_add_u32 m0, s41, s36
    s_nop 0
    buffer_load_dwordx4 v5, s[20:23], s42 offen offset:0 lds
    buffer_load_dwordx4 v5, s[20:23], s42 offen offset:1024 lds
    buffer_load_dwordx4 v5, s[20:23], s42 offen offset:2048 lds
    buffer_load_dwordx4 v5, s[20:23], s42 offen offset:3072 lds
    s_xor_b32 s40, s40, 32768
L_k_qproj_kernel_nodma:
    v_add_u32 v8, s40, v6
    v_add_u32 v9, s40, v7
    ds_read_b128 v[16:19], v8 offset:0
    ds_read_b128 v[20:23], v8 offset:4096
    ds_read_b128 v[24:27], v9 offset:0
    ds_read_b128 v[28:31], v9 offset:4096
    ds_read_b128 v[32:35], v8 offset:1024
    ds_read_b128 v[36:39], v8 offset:5120
    ds_read_b128 v[40:43], v9 offset:1024
    ds_read_b128 v[44:47], v9 offset:5120
    s_waitcnt lgkmcnt(4)
    v_mfma_f32_32x32x16_bf16 v[64:79], v[16:19], v[24:27], v[64:79]
    v_mfma_f32_32x32x16_bf16 v[80:95], v[16:19], v[28:31], v[80:95]
    v_mfma_f32_32x32x16_bf16 v[96:111], v[20:23], v[24:27], v[96:111]
    v_mfma_f32_32x32x16_bf16 v[112:127], v[20:23], v[28:31], v[112:127]
    ds_read_b128 v[16:19], v8 offset:2048
    ds_read_b128 v[20:23], v8 offset:6144
    ds_read_b128 v[24:27], v9 offset:2048
    ds_read_b128 v[28:31], v9 offset:6144
    s_waitcnt lgkmcnt(4)
    v_mfma_f32_32x32x16_bf16 v[64:79], v[32:35], v[40:43], v[64:79]
    v_mfma_f32_32x32x16_bf16 v[80:95], v[32:35], v[44:47], v[80:95]
    v_mfma_f32_32x32x16_bf16 v[96:111], v[36:39], v[40:43], v[96:111]
    v_mfma_f32_32x32x16_bf16 v[112:127], v[36:39], v[44:47], v[112:127]
    ds_read_b128 v[32:35], v8 offset:3072
    ds_read_b128 v[36:39], v8 offset:7168
    ds_read_b128 v[40:43], v9 offset:3072
    ds_read_b128 v[44:47], v9 offset:7168
    s_waitcnt lgkmcnt(4)
    v_mfma_f32_32x32x16_bf16 v[64:79], v[16:19], v[24:27], v[64:79]
    v_mfma_f32_32x32x16_bf16 v[80:95], v[16:19], v[28:31], v[80:95]
    v_mfma_f32_32x32x16_bf16 v[96:111], v[20:23], v[24:27], v[96:111]
    v_mfma_f32_32x32x16_bf16 v[112:127], v[20:23], v[28:31], v[112:127]
    s_waitcnt lgkmcnt(0)
    v_mfma_f32_32x32x16_bf16 v[64:79], v[32:35], v[40:43], v[64:79]
    v_mfma_f32_32x32x16_bf16 v[80:95], v[32:35], v[44:47], v[80:95]
    v_mfma_f32_32x32x16_bf16 v[96:111], v[36:39], v[40:43], v[96:111]
    v_mfma_f32_32x32x16_bf16 v[112:127], v[36:39], v[44:47], v[112:127]
    s_xor_b32 s40, s40, 32768
    s_add_u32 s43, s43, 1
    s_cmp_lt_u32 s43, 8
    s_cbranch_scc1 L_k_qproj_kernel_loop
    s_nop 15
    s_nop 3
    v_and_b32 v10, 31, v2
    v_lshrrev_b32 v11, 5, v2
    v_cvt_pk_bf16_f32 v12, v64, v65
    v_cvt_pk_bf16_f32 v13, v66, v67
    s_lshl_b32 s45, s29, 6
    s_lshl_b32 s46, s28, 2
    s_add_u32 s45, s45, s46
    s_add_u32 s45, s45, 0
    s_lshr_b32 s46, s32, 1
    s_lshl_b32 s46, s46, 1
    s_add_u32 s45, s45, s46
    s_lshl_b32 s45, s45, 3
    s_and_b32 s46, s32, 1
    s_lshl_b32 s46, s46, 2
    s_add_u32 s45, s45, s46
    s_add_u32 s45, s45, 0
    s_lshl_b32 s45, s45, 10
    v_lshl_add_u32 v14, v10, 4, s45
    v_lshl_add_u32 v14, v11, 3, v14
    buffer_store_dwordx2 v[12:13], v14, s[24:27], 0 offen offset:0
    s_nop 1
    v_cvt_pk_bf16_f32 v12, v68, v69
    v_cvt_pk_bf16_f32 v13, v70, v71
    s_lshl_b32 s45, s29, 6
    s_lshl_b32 s46, s28, 2
    s_add_u32 s45, s45, s46
    s_add_u32 s45, s45, 0
    s_lshr_b32 s46, s32, 1
    s_lshl_b32 s46, s46, 1
    s_add_u32 s45, s45, s46
    s_lshl_b32 s45, s45, 3
    s_and_b32 s46, s32, 1
    s_lshl_b32 s46, s46, 2
    s_add_u32 s45, s45, s46
    s_add_u32 s45, s45, 0
    s_lshl_b32 s45, s45, 10
    v_lshl_add_u32 v14, v10, 4, s45
    v_lshl_add_u32 v14, v11, 3, v14
    buffer_store_dwordx2 v[12:13], v14, s[24:27], 0 offen offset:512
    s_nop 1
    v_cvt_pk_bf16_f32 v12, v72, v73
    v_cvt_pk_bf16_f32 v13, v74, v75
    s_lshl_b32 s45, s29, 6
    s_lshl_b32 s46, s28, 2
    s_add_u32 s45, s45, s46
    s_add_u32 s45, s45, 0
    s_lshr_b32 s46, s32, 1
    s_lshl_b32 s46, s46, 1
    s_add_u32 s45, s45, s46
    s_lshl_b32 s45, s45, 3
    s_and_b32 s46, s32, 1
    s_lshl_b32 s46, s46, 2
    s_add_u32 s45, s45, s46
    s_add_u32 s45, s45, 1
    s_lshl_b32 s45, s45, 10
    v_lshl_add_u32 v14, v10, 4, s45
    v_lshl_add_u32 v14, v11, 3, v14
    buffer_store_dwordx2 v[12:13], v14, s[24:27], 0 offen offset:0
    s_nop 1
    v_cvt_pk_bf16_f32 v12, v76, v77
    v_cvt_pk_bf16_f32 v13, v78, v79
    s_lshl_b32 s45, s29, 6
    s_lshl_b32 s46, s28, 2
    s_add_u32 s45, s45, s46
    s_add_u32 s45, s45, 0
    s_lshr_b32 s46, s32, 1
    s_lshl_b32 s46, s46, 1
    s_add_u32 s45, s45, s46
    s_lshl_b32 s45, s45, 3
    s_and_b32 s46, s32, 1
    s_lshl_b32 s46, s46, 2
    s_add_u32 s45, s45, s46
    s_add_u32 s45, s45, 1
    s_lshl_b32 s45, s45, 10
    v_lshl_add_u32 v14, v10, 4, s45
    v_lshl_add_u32 v14, v11, 3, v14
    buffer_store_dwordx2 v[12:13], v14, s[24:27], 0 offen offset:512
    s_nop 1
    v_cvt_pk_bf16_f32 v12, v80, v81
    v_cvt_pk_bf16_f32 v13, v82, v83
    s_lshl_b32 s45, s29, 6
    s_lshl_b32 s46, s28, 2
    s_add_u32 s45, s45, s46
    s_add_u32 s45, s45, 1
    s_lshr_b32 s46, s32, 1
    s_lshl_b32 s46, s46, 1
    s_add_u32 s45, s45, s46
    s_lshl_b32 s45, s45, 3
    s_and_b32 s46, s32, 1
    s_lshl_b32 s46, s46, 2
    s_add_u32 s45, s45, s46
    s_add_u32 s45, s45, 0
    s_lshl_b32 s45, s45, 10
    v_lshl_add_u32 v14, v10, 4, s45
    v_lshl_add_u32 v14, v11, 3, v14
    buffer_store_dwordx2 v[12:13], v14, s[24:27], 0 offen offset:0
    s_nop 1
    v_cvt_pk_bf16_f32 v12, v84, v85
    v_cvt_pk_bf16_f32 v13, v86, v87
    s_lshl_b32 s45, s29, 6
    s_lshl_b32 s46, s28, 2
    s_add_u32 s45, s45, s46
    s_add_u32 s45, s45, 1
    s_lshr_b32 s46, s32, 1
    s_lshl_b32 s46, s46, 1
    s_add_u32 s45, s45, s46
    s_lshl_b32 s45, s45, 3
    s_and_b32 s46, s32, 1
    s_lshl_b32 s46, s46, 2
    s_add_u32 s45, s45, s46
    s_add_u32 s45, s45, 0
    s_lshl_b32 s45, s45, 10
    v_lshl_add_u32 v14, v10, 4, s45
    v_lshl_add_u32 v14, v11, 3, v14
    buffer_store_dwordx2 v[12:13], v14, s[24:27], 0 offen offset:512
    s_nop 1
    v_cvt_pk_bf16_f32 v12, v88, v89
    v_cvt_pk_bf16_f32 v13, v90, v91
    s_lshl_b32 s45, s29, 6
    s_lshl_b32 s46, s28, 2
    s_add_u32 s45, s45, s46
    s_add_u32 s45, s45, 1
    s_lshr_b32 s46, s32, 1
    s_lshl_b32 s46, s46, 1
    s_add_u32 s45, s45, s46
    s_lshl_b32 s45, s45, 3
    s_and_b32 s46, s32, 1
    s_lshl_b32 s46, s46, 2
    s_add_u32 s45, s45, s46
    s_add_u32 s45, s45, 1
    s_lshl_b32 s45, s45, 10
    v_lshl_add_u32 v14, v10, 4, s45
    v_lshl_add_u32 v14, v11, 3, v14
    buffer_store_dwordx2 v[12:13], v14, s[24:27], 0 offen offset:0
    s_nop 1
    v_cvt_pk_bf16_f32 v12, v92, v93
    v_cvt_pk_bf16_f32 v13, v94, v95
    s_lshl_b32 s45, s29, 6
    s_lshl_b32 s46, s28, 2
    s_add_u32 s45, s45, s46
    s_add_u32 s45, s45, 1
    s_lshr_b32 s46, s32, 1
    s_lshl_b32 s46, s46, 1
    s_add_u32 s45, s45, s46
    s_lshl_b32 s45, s45, 3
    s_and_b32 s46, s32, 1
    s_lshl_b32 s46, s46, 2
    s_add_u32 s45, s45, s46
    s_add_u32 s45, s45, 1
    s_lshl_b32 s45, s45, 10
    v_lshl_add_u32 v14, v10, 4, s45
    v_lshl_add_u32 v14, v11, 3, v14
    buffer_store_dwordx2 v[12:13], v14, s[24:27], 0 offen offset:512
    s_nop 1
    v_cvt_pk_bf16_f32 v12, v96, v97
    v_cvt_pk_bf16_f32 v13, v98, v99
    s_lshl_b32 s45, s29, 6
    s_lshl_b32 s46, s28, 2
    s_add_u32 s45, s45, s46
    s_add_u32 s45, s45, 0
    s_lshr_b32 s46, s32, 1
    s_lshl_b32 s46, s46, 1
    s_add_u32 s45, s45, s46
    s_lshl_b32 s45, s45, 3
    s_and_b32 s46, s32, 1
    s_lshl_b32 s46, s46, 2
    s_add_u32 s45, s45, s46
    s_add_u32 s45, s45, 2
    s_lshl_b32 s45, s45, 10
    v_lshl_add_u32 v14, v10, 4, s45
    v_lshl_add_u32 v14, v11, 3, v14
    buffer_store_dwordx2 v[12:13], v14, s[24:27], 0 offen offset:0
    s_nop 1
    v_cvt_pk_bf16_f32 v12, v100, v101
    v_cvt_pk_bf16_f32 v13, v102, v103
    s_lshl_b32 s45, s29, 6
    s_lshl_b32 s46, s28, 2
    s_add_u32 s45, s45, s46
    s_add_u32 s45, s45, 0
    s_lshr_b32 s46, s32, 1
    s_lshl_b32 s46, s46, 1
    s_add_u32 s45, s45, s46
    s_lshl_b32 s45, s45, 3
    s_and_b32 s46, s32, 1
    s_lshl_b32 s46, s46, 2
    s_add_u32 s45, s45, s46
    s_add_u32 s45, s45, 2
    s_lshl_b32 s45, s45, 10
    v_lshl_add_u32 v14, v10, 4, s45
    v_lshl_add_u32 v14, v11, 3, v14
    buffer_store_dwordx2 v[12:13], v14, s[24:27], 0 offen offset:512
    s_nop 1
    v_cvt_pk_bf16_f32 v12, v104, v105
    v_cvt_pk_bf16_f32 v13, v106, v107
    s_lshl_b32 s45, s29, 6
    s_lshl_b32 s46, s28, 2
    s_add_u32 s45, s45, s46
    s_add_u32 s45, s45, 0
    s_lshr_b32 s46, s32, 1
    s_lshl_b32 s46, s46, 1
    s_add_u32 s45, s45, s46
    s_lshl_b32 s45, s45, 3
    s_and_b32 s46, s32, 1
    s_lshl_b32 s46, s46, 2
    s_add_u32 s45, s45, s46
    s_add_u32 s45, s45, 3
    s_lshl_b32 s45, s45, 10
    v_lshl_add_u32 v14, v10, 4, s45
    v_lshl_add_u32 v14, v11, 3, v14
    buffer_store_dwordx2 v[12:13], v14, s[24:27], 0 offen offset:0
    s_nop 1
    v_cvt_pk_bf16_f32 v12, v108, v109
    v_cvt_pk_bf16_f32 v13, v110, v111
    s_lshl_b32 s45, s29, 6
    s_lshl_b32 s46, s28, 2
    s_add_u32 s45, s45, s46
    s_add_u32 s45, s45, 0
    s_lshr_b32 s46, s32, 1
    s_lshl_b32 s46, s46, 1
    s_add_u32 s45, s45, s46
    s_lshl_b32 s45, s45, 3
    s_and_b32 s46, s32, 1
    s_lshl_b32 s46, s46, 2
    s_add_u32 s45, s45, s46
    s_add_u32 s45, s45, 3
    s_lshl_b32 s45, s45, 10
    v_lshl_add_u32 v14, v10, 4, s45
    v_lshl_add_u32 v14, v11, 3, v14
    buffer_store_dwordx2 v[12:13], v14, s[24:27], 0 offen offset:512
    s_nop 1
    v_cvt_pk_bf16_f32 v12, v112, v113
    v_cvt_pk_bf16_f32 v13, v114, v115
    s_lshl_b32 s45, s29, 6
    s_lshl_b32 s46, s28, 2
    s_add_u32 s45, s45, s46
    s_add_u32 s45, s45, 1
    s_lshr_b32 s46, s32, 1
    s_lshl_b32 s46, s46, 1
    s_add_u32 s45, s45, s46
    s_lshl_b32 s45, s45, 3
    s_and_b32 s46, s32, 1
    s_lshl_b32 s46, s46, 2
    s_add_u32 s45, s45, s46
    s_add_u32 s45, s45, 2
    s_lshl_b32 s45, s45, 10
    v_lshl_add_u32 v14, v10, 4, s45
    v_lshl_add_u32 v14, v11, 3, v14
    buffer_store_dwordx2 v[12:13], v14, s[24:27], 0 offen offset:0
    s_nop 1
    v_cvt_pk_bf16_f32 v12, v116, v117
    v_cvt_pk_bf16_f32 v13, v118, v119
    s_lshl_b32 s45, s29, 6
    s_lshl_b32 s46, s28, 2
    s_add_u32 s45, s45, s46
    s_add_u32 s45, s45, 1
    s_lshr_b32 s46, s32, 1
    s_lshl_b32 s46, s46, 1
    s_add_u32 s45, s45, s46
    s_lshl_b32 s45, s45, 3
    s_and_b32 s46, s32, 1
    s_lshl_b32 s46, s46, 2
    s_add_u32 s45, s45, s46
    s_add_u32 s45, s45, 2
    s_lshl_b32 s45, s45, 10
    v_lshl_add_u32 v14, v10, 4, s45
    v_lshl_add_u32 v14, v11, 3, v14
    buffer_store_dwordx2 v[12:13], v14, s[24:27], 0 offen offset:512
    s_nop 1
    v_cvt_pk_bf16_f32 v12, v120, v121
    v_cvt_pk_bf16_f32 v13, v122, v123
    s_lshl_b32 s45, s29, 6
    s_lshl_b32 s46, s28, 2
    s_add_u32 s45, s45, s46
    s_add_u32 s45, s45, 1
    s_lshr_b32 s46, s32, 1
    s_lshl_b32 s46, s46, 1
    s_add_u32 s45, s45, s46
    s_lshl_b32 s45, s45, 3
    s_and_b32 s46, s32, 1
    s_lshl_b32 s46, s46, 2
    s_add_u32 s45, s45, s46
    s_add_u32 s45, s45, 3
    s_lshl_b32 s45, s45, 10
    v_lshl_add_u32 v14, v10, 4, s45
    v_lshl_add_u32 v14, v11, 3, v14
    buffer_store_dwordx2 v[12:13], v14, s[24:27], 0 offen offset:0
    s_nop 1
    v_cvt_pk_bf16_f32 v12, v124, v125
    v_cvt_pk_bf16_f32 v13, v126, v127
    s_lshl_b32 s45, s29, 6
    s_lshl_b32 s46, s28, 2
    s_add_u32 s45, s45, s46
    s_add_u32 s45, s45, 1
    s_lshr_b32 s46, s32, 1
    s_lshl_b32 s46, s46, 1
    s_add_u32 s45, s45, s46
    s_lshl_b32 s45, s45, 3
    s_and_b32 s46, s32, 1
    s_lshl_b32 s46, s46, 2
    s_add_u32 s45, s45, s46
    s_add_u32 s45, s45, 3
    s_lshl_b32 s45, s45, 10
    v_lshl_add_u32 v14, v10, 4, s45
    v_lshl_add_u32 v14, v11, 3, v14
    buffer_store_dwordx2 v[12:13], v14, s[24:27], 0 offen offset:512
    s_nop 1
    s_waitcnt vmcnt(0)
L_k_qproj_kernel_done:
    s_endpgm
.globl k_attn_kernel
.p2align 8
.type k_attn_kernel,@function
k_attn_kernel:
    s_cmp_ge_u32 s2, 256
    s_cbranch_scc1 L_k_attn_kernel_done
    s_load_dwordx2 s[8:9], s[0:1], 104
    s_waitcnt lgkmcnt(0)
    s_add_u32 s12, s8, 1048576
    s_addc_u32 s13, s9, 0
    s_and_b32 s13, s13, 0xffff
    s_mov_b32 s14, 4194304
    s_mov_b32 s15, 0x00020000
    s_add_u32 s16, s8, 5242880
    s_addc_u32 s17, s9, 0
    s_and_b32 s17, s17, 0xffff
    s_mov_b32 s18, 4194304
    s_mov_b32 s19, 0x00020000
    s_add_u32 s20, s8, 26214400
    s_addc_u32 s21, s9, 0
    s_and_b32 s21, s21, 0xffff
    s_mov_b32 s22, 16777216
    s_mov_b32 s23, 0x00020000
    s_add_u32 s24, s8, 42991616
    s_addc_u32 s25, s9, 0
    s_and_b32 s25, s25, 0xffff
    s_mov_b32 s26, 16777216
    s_mov_b32 s27, 0x00020000
    s_and_b32 s28, s2, 7
    s_lshr_b32 s29, s2, 3
    s_and_b32 s29, s29, 3
    s_lshl_b32 s30, s28, 2
    s_add_u32 s29, s29, s30
    s_lshr_b32 s30, s2, 5
    v_lshrrev_b32 v1, 6, v0
    v_and_b32 v2, 63, v0
    s_nop 0
    v_readfirstlane_b32 s32, v1
    v_lshlrev_b32 v3, 4, v2
    s_lshl_b32 s33, s29, 6
    s_lshl_b32 s34, s30, 3
    s_add_u32 s33, s33, s34
    s_add_u32 s33, s33, s32
    s_lshl_b32 s33, s33, 13
    v_add_u32 v4, s33, v3
    buffer_load_dwordx4 v[32:35], v4, s[20:23], 0 offen offset:0
    buffer_load_dwordx4 v[36:39], v4, s[20:23], 0 offen offset:1024
    buffer_load_dwordx4 v[40:43], v4, s[20:23], 0 offen offset:2048
    buffer_load_dwordx4 v[44:47], v4, s[20:23], 0 offen offset:3072
    v_add_u32 v4, 4096, v4
    buffer_load_dwordx4 v[48:51], v4, s[20:23], 0 offen offset:0
    buffer_load_dwordx4 v[52:55], v4, s[20:23], 0 offen offset:1024
    buffer_load_dwordx4 v[56:59], v4, s[20:23], 0 offen offset:2048
    buffer_load_dwordx4 v[60:63], v4, s[20:23], 0 offen offset:3072
    s_lshl_b32 s34, s28, 19
    s_lshl_b32 s35, s32, 11
    s_add_u32 s34, s34, s35
    v_add_u32 v5, s34, v3
    v_mov_b32 v64, 0
    v_mov_b32 v65, 0
    v_mov_b32 v66, 0
    v_mov_b32 v67, 0
    v_mov_b32 v68, 0
    v_mov_b32 v69, 0
    v_mov_b32 v70, 0
    v_mov_b32 v71, 0
    v_mov_b32 v72, 0
    v_mov_b32 v73, 0
    v_mov_b32 v74, 0
    v_mov_b32 v75, 0
    v_mov_b32 v76, 0
    v_mov_b32 v77, 0
    v_mov_b32 v78, 0
    v_mov_b32 v79, 0
    v_mov_b32 v80, 0
    v_mov_b32 v81, 0
    v_mov_b32 v82, 0
    v_mov_b32 v83, 0
    v_mov_b32 v84, 0
    v_mov_b32 v85, 0
    v_mov_b32 v86, 0
    v_mov_b32 v87, 0
    v_mov_b32 v88, 0
    v_mov_b32 v89, 0
    v_mov_b32 v90, 0
    v_mov_b32 v91, 0
    v_mov_b32 v92, 0
    v_mov_b32 v93, 0
    v_mov_b32 v94, 0
    v_mov_b32 v95, 0
    v_mov_b32 v96, 0
    v_mov_b32 v97, 0
    v_mov_b32 v98, 0
    v_mov_b32 v99, 0
    v_mov_b32 v100, 0
    v_mov_b32 v101, 0
    v_mov_b32 v102, 0
    v_mov_b32 v103, 0
    v_mov_b32 v104, 0
    v_mov_b32 v105, 0
    v_mov_b32 v106, 0
    v_mov_b32 v107, 0
    v_mov_b32 v108, 0
    v_mov_b32 v109, 0
    v_mov_b32 v110, 0
    v_mov_b32 v111, 0
    v_mov_b32 v112, 0
    v_mov_b32 v113, 0
    v_mov_b32 v114, 0
    v_mov_b32 v115, 0
    v_mov_b32 v116, 0
    v_mov_b32 v117, 0
    v_mov_b32 v118, 0
    v_mov_b32 v119, 0
    v_mov_b32 v120, 0
    v_mov_b32 v121, 0
    v_mov_b32 v122, 0
    v_mov_b32 v123, 0
    v_mov_b32 v124, 0
    v_mov_b32 v125, 0
    v_mov_b32 v126, 0
    v_mov_b32 v127, 0
    v_mov_b32 v6, 0xff800000
    v_mov_b32 v7, 0
    s_mov_b32 s44, 0x3e0553f5
    s_mov_b32 s40, 0
    s_mov_b32 s42, 0
    s_add_u32 m0, s40, s35
    s_nop 0
    buffer_load_dwordx4 v5, s[12:15], s42 offen lds
    buffer_load_dwordx4 v5, s[12:15], s42 offen offset:1024 lds
    s_add_u32 s41, s40, 16384
    s_add_u32 m0, s41, s35
    s_nop 0
    buffer_load_dwordx4 v5, s[16:19], s42 offen lds
    buffer_load_dwordx4 v5, s[16:19], s42 offen offset:1024 lds
    s_mov_b32 s43, 0
L_k_attn_kernel_loop:
    s_waitcnt vmcnt(0)
    s_barrier
    s_add_u32 s45, s43, 1
    s_cmp_lt_u32 s45, 32
    s_cbranch_scc0 L_k_attn_kernel_nodma
    s_xor_b32 s40, s40, 32768
    s_add_u32 s42, s42, 16384
    s_add_u32 m0, s40, s35
    s_nop 0
    buffer_load_dwordx4 v5, s[12:15], s42 offen lds
    buffer_load_dwordx4 v5, s[12:15], s42 offen offset:1024 lds
    s_add_u32 s41, s40, 16384
    s_add_u32 m0, s41, s35
    s_nop 0
    buffer_load_dwordx4 v5, s[16:19], s42 offen lds
    buffer_load_dwordx4 v5, s[16:19], s42 offen offset:1024 lds
    s_xor_b32 s40, s40, 32768
L_k_attn_kernel_nodma:
    v_add_u32 v8, s40, v3
    ds_read_b128 v[176:179], v8 offset:0
    ds_read_b128 v[180:183], v8 offset:1024
    ds_read_b128 v[184:187], v8 offset:2048
    ds_read_b128 v[188:191], v8 offset:3072
    ds_read_b128 v[192:195], v8 offset:4096
    ds_read_b128 v[196:199], v8 offset:5120
    ds_read_b128 v[200:203], v8 offset:6144
    ds_read_b128 v[204:207], v8 offset:7168
    s_waitcnt lgkmcnt(7)
    v_mfma_f32_32x32x16_bf16 v[128:143], v[176:179], v[32:35], 0
    s_waitcnt lgkmcnt(6)
    v_mfma_f32_32x32x16_bf16 v[128:143], v[180:183], v[36:39], v[128:143]
    s_waitcnt lgkmcnt(5)
    v_mfma_f32_32x32x16_bf16 v[128:143], v[184:187], v[40:43], v[128:143]
    s_waitcnt lgkmcnt(4)
    v_mfma_f32_32x32x16_bf16 v[128:143], v[188:191], v[44:47], v[128:143]
    s_waitcnt lgkmcnt(3)
    v_mfma_f32_32x32x16_bf16 v[128:143], v[192:195], v[48:51], v[128:143]
    s_waitcnt lgkmcnt(2)
    v_mfma_f32_32x32x16_bf16 v[128:143], v[196:199], v[52:55], v[128:143]
    s_waitcnt lgkmcnt(1)
    v_mfma_f32_32x32x16_bf16 v[128:143], v[200:203], v[56:59], v[128:143]
    s_waitcnt lgkmcnt(0)
    v_mfma_f32_32x32x16_bf16 v[128:143], v[204:207], v[60:63], v[128:143]
    ds_read_b128 v[176:179], v8 offset:8192
    ds_read_b128 v[180:183], v8 offset:9216
    ds_read_b128 v[184:187], v8 offset:10240
    ds_read_b128 v[188:191], v8 offset:11264
    ds_read_b128 v[192:195], v8 offset:12288
    ds_read_b128 v[196:199], v8 offset:13312
    ds_read_b128 v[200:203], v8 offset:14336
    ds_read_b128 v[204:207], v8 offset:15360
    s_waitcnt lgkmcnt(7)
    v_mfma_f32_32x32x16_bf16 v[144:159], v[176:179], v[32:35], 0
    s_waitcnt lgkmcnt(6)
    v_mfma_f32_32x32x16_bf16 v[144:159], v[180:183], v[36:39], v[144:159]
    s_waitcnt lgkmcnt(5)
    v_mfma_f32_32x32x16_bf16 v[144:159], v[184:187], v[40:43], v[144:159]
    s_waitcnt lgkmcnt(4)
    v_mfma_f32_32x32x16_bf16 v[144:159], v[188:191], v[44:47], v[144:159]
    s_waitcnt lgkmcnt(3)
    v_mfma_f32_32x32x16_bf16 v[144:159], v[192:195], v[48:51], v[144:159]
    s_waitcnt lgkmcnt(2)
    v_mfma_f32_32x32x16_bf16 v[144:159], v[196:199], v[52:55], v[144:159]
    s_waitcnt lgkmcnt(1)
    v_mfma_f32_32x32x16_bf16 v[144:159], v[200:203], v[56:59], v[144:159]
    s_waitcnt lgkmcnt(0)
    v_mfma_f32_32x32x16_bf16 v[144:159], v[204:207], v[60:63], v[144:159]
    s_nop 15
    v_max_f32 v9, v128, v129
    v_max3_f32 v9, v9, v130, v131
    v_max3_f32 v9, v9, v132, v133
    v_max3_f32 v9, v9, v134, v135
    v_max3_f32 v9, v9, v136, v137
    v_max3_f32 v9, v9, v138, v139
    v_max3_f32 v9, v9, v140, v141
    v_max3_f32 v9, v9, v142, v143
    v_max3_f32 v9, v9, v144, v145
    v_max3_f32 v9, v9, v146, v147
    v_max3_f32 v9, v9, v148, v149
    v_max3_f32 v9, v9, v150, v151
    v_max3_f32 v9, v9, v152, v153
    v_max3_f32 v9, v9, v154, v155
    v_max3_f32 v9, v9, v156, v157
    v_max3_f32 v9, v9, v158, v159
    v_mov_b32 v10, v9
    s_nop 1
    v_permlane32_swap_b32 v9, v10
    v_max_f32 v9, v9, v10
    v_max_f32 v9, v9, v6
    v_sub_f32 v10, v9, v6
    v_mul_f32 v10, s44, v10
    v_mov_b32 v11, 0x41000000
    v_cmp_gt_f32 vcc, v10, v11
    s_cbranch_vccz L_k_attn_kernel_norescale
    v_sub_f32 v10, v6, v9
    v_mul_f32 v10, s44, v10
    v_exp_f32 v10, v10
    v_mov_b32 v6, v9
    v_mul_f32 v7, v7, v10
    v_mul_f32 v64, v64, v10
    v_mul_f32 v65, v65, v10
    v_mul_f32 v66, v66, v10
    v_mul_f32 v67, v67, v10
    v_mul_f32 v68, v68, v10
    v_mul_f32 v69, v69, v10
    v_mul_f32 v70, v70, v10
    v_mul_f32 v71, v71, v10
    v_mul_f32 v72, v72, v10
    v_mul_f32 v73, v73, v10
    v_mul_f32 v74, v74, v10
    v_mul_f32 v75, v75, v10
    v_mul_f32 v76, v76, v10
    v_mul_f32 v77, v77, v10
    v_mul_f32 v78, v78, v10
    v_mul_f32 v79, v79, v10
    v_mul_f32 v80, v80, v10
    v_mul_f32 v81, v81, v10
    v_mul_f32 v82, v82, v10
    v_mul_f32 v83, v83, v10
    v_mul_f32 v84, v84, v10
    v_mul_f32 v85, v85, v10
    v_mul_f32 v86, v86, v10
    v_mul_f32 v87, v87, v10
    v_mul_f32 v88, v88, v10
    v_mul_f32 v89, v89, v10
    v_mul_f32 v90, v90, v10
    v_mul_f32 v91, v91, v10
    v_mul_f32 v92, v92, v10
    v_mul_f32 v93, v93, v10
    v_mul_f32 v94, v94, v10
    v_mul_f32 v95, v95, v10
    v_mul_f32 v96, v96, v10
    v_mul_f32 v97, v97, v10
    v_mul_f32 v98, v98, v10
    v_mul_f32 v99, v99, v10
    v_mul_f32 v100, v100, v10
    v_mul_f32 v101, v101, v10
    v_mul_f32 v102, v102, v10
    v_mul_f32 v103, v103, v10
    v_mul_f32 v104, v104, v10
    v_mul_f32 v105, v105, v10
    v_mul_f32 v106, v106, v10
    v_mul_f32 v107, v107, v10
    v_mul_f32 v108, v108, v10
    v_mul_f32 v109, v109, v10
    v_mul_f32 v110, v110, v10
    v_mul_f32 v111, v111, v10
    v_mul_f32 v112, v112, v10
    v_mul_f32 v113, v113, v10
    v_mul_f32 v114, v114, v10
    v_mul_f32 v115, v115, v10
    v_mul_f32 v116, v116, v10
    v_mul_f32 v117, v117, v10
    v_mul_f32 v118, v118, v10
    v_mul_f32 v119, v119, v10
    v_mul_f32 v120, v120, v10
    v_mul_f32 v121, v121, v10
    v_mul_f32 v122, v122, v10
    v_mul_f32 v123, v123, v10
    v_mul_f32 v124, v124, v10
    v_mul_f32 v125, v125, v10
    v_mul_f32 v126, v126, v10
    v_mul_f32 v127, v127, v10
L_k_attn_kernel_norescale:
    v_mul_f32 v11, s44, v6
    v_fma_f32 v128, v128, s44, -v11
    v_exp_f32 v128, v128
    v_fma_f32 v129, v129, s44, -v11
    v_exp_f32 v129, v129
    v_fma_f32 v130, v130, s44, -v11
    v_exp_f32 v130, v130
    v_fma_f32 v131, v131, s44, -v11
    v_exp_f32 v131, v131
    v_fma_f32 v132, v132, s44, -v11
    v_exp_f32 v132, v132
    v_fma_f32 v133, v133, s44, -v11
    v_exp_f32 v133, v133
    v_fma_f32 v134, v134, s44, -v11
    v_exp_f32 v134, v134
    v_fma_f32 v135, v135, s44, -v11
    v_exp_f32 v135, v135
    v_fma_f32 v136, v136, s44, -v11
    v_exp_f32 v136, v136
    v_fma_f32 v137, v137, s44, -v11
    v_exp_f32 v137, v137
    v_fma_f32 v138, v138, s44, -v11
    v_exp_f32 v138, v138
    v_fma_f32 v139, v139, s44, -v11
    v_exp_f32 v139, v139
    v_fma_f32 v140, v140, s44, -v11
    v_exp_f32 v140, v140
    v_fma_f32 v141, v141, s44, -v11
    v_exp_f32 v141, v141
    v_fma_f32 v142, v142, s44, -v11
    v_exp_f32 v142, v142
    v_fma_f32 v143, v143, s44, -v11
    v_exp_f32 v143, v143
    v_fma_f32 v144, v144, s44, -v11
    v_exp_f32 v144, v144
    v_fma_f32 v145, v145, s44, -v11
    v_exp_f32 v145, v145
    v_fma_f32 v146, v146, s44, -v11
    v_exp_f32 v146, v146
    v_fma_f32 v147, v147, s44, -v11
    v_exp_f32 v147, v147
    v_fma_f32 v148, v148, s44, -v11
    v_exp_f32 v148, v148
    v_fma_f32 v149, v149, s44, -v11
    v_exp_f32 v149, v149
    v_fma_f32 v150, v150, s44, -v11
    v_exp_f32 v150, v150
    v_fma_f32 v151, v151, s44, -v11
    v_exp_f32 v151, v151
    v_fma_f32 v152, v152, s44, -v11
    v_exp_f32 v152, v152
    v_fma_f32 v153, v153, s44, -v11
    v_exp_f32 v153, v153
    v_fma_f32 v154, v154, s44, -v11
    v_exp_f32 v154, v154
    v_fma_f32 v155, v155, s44, -v11
    v_exp_f32 v155, v155
    v_fma_f32 v156, v156, s44, -v11
    v_exp_f32 v156, v156
    v_fma_f32 v157, v157, s44, -v11
    v_exp_f32 v157, v157
    v_fma_f32 v158, v158, s44, -v11
    v_exp_f32 v158, v158
    v_fma_f32 v159, v159, s44, -v11
    v_exp_f32 v159, v159
    s_nop 0
    v_add_f32 v7, v7, v128
    v_add_f32 v7, v7, v129
    v_add_f32 v7, v7, v130
    v_add_f32 v7, v7, v131
    v_add_f32 v7, v7, v132
    v_add_f32 v7, v7, v133
    v_add_f32 v7, v7, v134
    v_add_f32 v7, v7, v135
    v_add_f32 v7, v7, v136
    v_add_f32 v7, v7, v137
    v_add_f32 v7, v7, v138
    v_add_f32 v7, v7, v139
    v_add_f32 v7, v7, v140
    v_add_f32 v7, v7, v141
    v_add_f32 v7, v7, v142
    v_add_f32 v7, v7, v143
    v_add_f32 v7, v7, v144
    v_add_f32 v7, v7, v145
    v_add_f32 v7, v7, v146
    v_add_f32 v7, v7, v147
    v_add_f32 v7, v7, v148
    v_add_f32 v7, v7, v149
    v_add_f32 v7, v7, v150
    v_add_f32 v7, v7, v151
    v_add_f32 v7, v7, v152
    v_add_f32 v7, v7, v153
    v_add_f32 v7, v7, v154
    v_add_f32 v7, v7, v155
    v_add_f32 v7, v7, v156
    v_add_f32 v7, v7, v157
    v_add_f32 v7, v7, v158
    v_add_f32 v7, v7, v159
    v_cvt_pk_bf16_f32 v160, v128, v129
    v_cvt_pk_bf16_f32 v161, v130, v131
    v_cvt_pk_bf16_f32 v162, v132, v133
    v_cvt_pk_bf16_f32 v163, v134, v135
    v_cvt_pk_bf16_f32 v164, v136, v137
    v_cvt_pk_bf16_f32 v165, v138, v139
    v_cvt_pk_bf16_f32 v166, v140, v141
    v_cvt_pk_bf16_f32 v167, v142, v143
    v_cvt_pk_bf16_f32 v168, v144, v145
    v_cvt_pk_bf16_f32 v169, v146, v147
    v_cvt_pk_bf16_f32 v170, v148, v149
    v_cvt_pk_bf16_f32 v171, v150, v151
    v_cvt_pk_bf16_f32 v172, v152, v153
    v_cvt_pk_bf16_f32 v173, v154, v155
    v_cvt_pk_bf16_f32 v174, v156, v157
    v_cvt_pk_bf16_f32 v175, v158, v159
    ds_read_b128 v[176:179], v8 offset:16384
    ds_read_b128 v[180:183], v8 offset:17408
    ds_read_b128 v[184:187], v8 offset:18432
    ds_read_b128 v[188:191], v8 offset:19456
    s_waitcnt lgkmcnt(3)
    v_mfma_f32_32x32x16_bf16 v[64:79], v[176:179], v[160:163], v[64:79]
    s_waitcnt lgkmcnt(2)
    v_mfma_f32_32x32x16_bf16 v[80:95], v[180:183], v[160:163], v[80:95]
    s_waitcnt lgkmcnt(1)
    v_mfma_f32_32x32x16_bf16 v[96:111], v[184:187], v[160:163], v[96:111]
    s_waitcnt lgkmcnt(0)
    v_mfma_f32_32x32x16_bf16 v[112:127], v[188:191], v[160:163], v[112:127]
    ds_read_b128 v[176:179], v8 offset:20480
    ds_read_b128 v[180:183], v8 offset:21504
    ds_read_b128 v[184:187], v8 offset:22528
    ds_read_b128 v[188:191], v8 offset:23552
    s_waitcnt lgkmcnt(3)
    v_mfma_f32_32x32x16_bf16 v[64:79], v[176:179], v[164:167], v[64:79]
    s_waitcnt lgkmcnt(2)
    v_mfma_f32_32x32x16_bf16 v[80:95], v[180:183], v[164:167], v[80:95]
    s_waitcnt lgkmcnt(1)
    v_mfma_f32_32x32x16_bf16 v[96:111], v[184:187], v[164:167], v[96:111]
    s_waitcnt lgkmcnt(0)
    v_mfma_f32_32x32x16_bf16 v[112:127], v[188:191], v[164:167], v[112:127]
    ds_read_b128 v[176:179], v8 offset:24576
    ds_read_b128 v[180:183], v8 offset:25600
    ds_read_b128 v[184:187], v8 offset:26624
    ds_read_b128 v[188:191], v8 offset:27648
    s_waitcnt lgkmcnt(3)
    v_mfma_f32_32x32x16_bf16 v[64:79], v[176:179], v[168:171], v[64:79]
    s_waitcnt lgkmcnt(2)
    v_mfma_f32_32x32x16_bf16 v[80:95], v[180:183], v[168:171], v[80:95]
    s_waitcnt lgkmcnt(1)
    v_mfma_f32_32x32x16_bf16 v[96:111], v[184:187], v[168:171], v[96:111]
    s_waitcnt lgkmcnt(0)
    v_mfma_f32_32x32x16_bf16 v[112:127], v[188:191], v[168:171], v[112:127]
    ds_read_b128 v[176:179], v8 offset:28672
    ds_read_b128 v[180:183], v8 offset:29696
    ds_read_b128 v[184:187], v8 offset:30720
    ds_read_b128 v[188:191], v8 offset:31744
    s_waitcnt lgkmcnt(3)
    v_mfma_f32_32x32x16_bf16 v[64:79], v[176:179], v[172:175], v[64:79]
    s_waitcnt lgkmcnt(2)
    v_mfma_f32_32x32x16_bf16 v[80:95], v[180:183], v[172:175], v[80:95]
    s_waitcnt lgkmcnt(1)
    v_mfma_f32_32x32x16_bf16 v[96:111], v[184:187], v[172:175], v[96:111]
    s_waitcnt lgkmcnt(0)
    v_mfma_f32_32x32x16_bf16 v[112:127], v[188:191], v[172:175], v[112:127]
    s_xor_b32 s40, s40, 32768
    s_add_u32 s43, s43, 1
    s_cmp_lt_u32 s43, 32
    s_cbranch_scc1 L_k_attn_kernel_loop
    s_nop 15
    v_mov_b32 v10, v7
    s_nop 1
    v_permlane32_swap_b32 v7, v10
    v_add_f32 v7, v7, v10
    v_rcp_f32 v7, v7
    s_nop 0
    v_and_b32 v10, 31, v2
    v_lshrrev_b32 v11, 5, v2
    s_lshl_b32 s45, s30, 3
    s_add_u32 s45, s45, s32
    s_lshl_b32 s45, s45, 8
    s_lshl_b32 s46, s29, 3
    s_add_u32 s45, s45, s46
    s_lshl_b32 s45, s45, 10
    v_lshl_add_u32 v14, v10, 4, s45
    v_lshl_add_u32 v14, v11, 3, v14
    v_mul_f32 v64, v64, v7
    v_mul_f32 v65, v65, v7
    v_mul_f32 v66, v66, v7
    v_mul_f32 v67, v67, v7
    v_cvt_pk_bf16_f32 v12, v64, v65
    v_cvt_pk_bf16_f32 v13, v66, v67
    buffer_store_dwordx2 v[12:13], v14, s[24:27], 0 offen offset:0
    s_nop 1
    v_mul_f32 v68, v68, v7
    v_mul_f32 v69, v69, v7
    v_mul_f32 v70, v70, v7
    v_mul_f32 v71, v71, v7
    v_cvt_pk_bf16_f32 v12, v68, v69
    v_cvt_pk_bf16_f32 v13, v70, v71
    buffer_store_dwordx2 v[12:13], v14, s[24:27], 0 offen offset:512
    s_nop 1
    v_mul_f32 v72, v72, v7
    v_mul_f32 v73, v73, v7
    v_mul_f32 v74, v74, v7
    v_mul_f32 v75, v75, v7
    v_cvt_pk_bf16_f32 v12, v72, v73
    v_cvt_pk_bf16_f32 v13, v74, v75
    buffer_store_dwordx2 v[12:13], v14, s[24:27], 0 offen offset:1024
    s_nop 1
    v_mul_f32 v76, v76, v7
    v_mul_f32 v77, v77, v7
    v_mul_f32 v78, v78, v7
    v_mul_f32 v79, v79, v7
    v_cvt_pk_bf16_f32 v12, v76, v77
    v_cvt_pk_bf16_f32 v13, v78, v79
    buffer_store_dwordx2 v[12:13], v14, s[24:27], 0 offen offset:1536
    s_nop 1
    v_mul_f32 v80, v80, v7
    v_mul_f32 v81, v81, v7
    v_mul_f32 v82, v82, v7
    v_mul_f32 v83, v83, v7
    v_cvt_pk_bf16_f32 v12, v80, v81
    v_cvt_pk_bf16_f32 v13, v82, v83
    buffer_store_dwordx2 v[12:13], v14, s[24:27], 0 offen offset:2048
    s_nop 1
    v_mul_f32 v84, v84, v7
    v_mul_f32 v85, v85, v7
    v_mul_f32 v86, v86, v7
    v_mul_f32 v87, v87, v7
    v_cvt_pk_bf16_f32 v12, v84, v85
    v_cvt_pk_bf16_f32 v13, v86, v87
    buffer_store_dwordx2 v[12:13], v14, s[24:27], 0 offen offset:2560
    s_nop 1
    v_mul_f32 v88, v88, v7
    v_mul_f32 v89, v89, v7
    v_mul_f32 v90, v90, v7
    v_mul_f32 v91, v91, v7
    v_cvt_pk_bf16_f32 v12, v88, v89
    v_cvt_pk_bf16_f32 v13, v90, v91
    buffer_store_dwordx2 v[12:13], v14, s[24:27], 0 offen offset:3072
    s_nop 1
    v_mul_f32 v92, v92, v7
    v_mul_f32 v93, v93, v7
    v_mul_f32 v94, v94, v7
    v_mul_f32 v95, v95, v7
    v_cvt_pk_bf16_f32 v12, v92, v93
    v_cvt_pk_bf16_f32 v13, v94, v95
    buffer_store_dwordx2 v[12:13], v14, s[24:27], 0 offen offset:3584
    s_nop 1
    v_mul_f32 v96, v96, v7
    v_mul_f32 v97, v97, v7
    v_mul_f32 v98, v98, v7
    v_mul_f32 v99, v99, v7
    v_cvt_pk_bf16_f32 v12, v96, v97
    v_cvt_pk_bf16_f32 v13, v98, v99
    s_mov_b32 s47, 4096
    buffer_store_dwordx2 v[12:13], v14, s[24:27], s47 offen offset:0
    s_nop 1
    v_mul_f32 v100, v100, v7
    v_mul_f32 v101, v101, v7
    v_mul_f32 v102, v102, v7
    v_mul_f32 v103, v103, v7
    v_cvt_pk_bf16_f32 v12, v100, v101
    v_cvt_pk_bf16_f32 v13, v102, v103
    s_mov_b32 s47, 4096
    buffer_store_dwordx2 v[12:13], v14, s[24:27], s47 offen offset:512
    s_nop 1
    v_mul_f32 v104, v104, v7
    v_mul_f32 v105, v105, v7
    v_mul_f32 v106, v106, v7
    v_mul_f32 v107, v107, v7
    v_cvt_pk_bf16_f32 v12, v104, v105
    v_cvt_pk_bf16_f32 v13, v106, v107
    s_mov_b32 s47, 4096
    buffer_store_dwordx2 v[12:13], v14, s[24:27], s47 offen offset:1024
    s_nop 1
    v_mul_f32 v108, v108, v7
    v_mul_f32 v109, v109, v7
    v_mul_f32 v110, v110, v7
    v_mul_f32 v111, v111, v7
    v_cvt_pk_bf16_f32 v12, v108, v109
    v_cvt_pk_bf16_f32 v13, v110, v111
    s_mov_b32 s47, 4096
    buffer_store_dwordx2 v[12:13], v14, s[24:27], s47 offen offset:1536
    s_nop 1
    v_mul_f32 v112, v112, v7
    v_mul_f32 v113, v113, v7
    v_mul_f32 v114, v114, v7
    v_mul_f32 v115, v115, v7
    v_cvt_pk_bf16_f32 v12, v112, v113
    v_cvt_pk_bf16_f32 v13, v114, v115
    s_mov_b32 s47, 4096
    buffer_store_dwordx2 v[12:13], v14, s[24:27], s47 offen offset:2048
    s_nop 1
    v_mul_f32 v116, v116, v7
    v_mul_f32 v117, v117, v7
    v_mul_f32 v118, v118, v7
    v_mul_f32 v119, v119, v7
    v_cvt_pk_bf16_f32 v12, v116, v117
    v_cvt_pk_bf16_f32 v13, v118, v119
    s_mov_b32 s47, 4096
    buffer_store_dwordx2 v[12:13], v14, s[24:27], s47 offen offset:2560
    s_nop 1
    v_mul_f32 v120, v120, v7
    v_mul_f32 v121, v121, v7
    v_mul_f32 v122, v122, v7
    v_mul_f32 v123, v123, v7
    v_cvt_pk_bf16_f32 v12, v120, v121
    v_cvt_pk_bf16_f32 v13, v122, v123
    s_mov_b32 s47, 4096
    buffer_store_dwordx2 v[12:13], v14, s[24:27], s47 offen offset:3072
    s_nop 1
    v_mul_f32 v124, v124, v7
    v_mul_f32 v125, v125, v7
    v_mul_f32 v126, v126, v7
    v_mul_f32 v127, v127, v7
    v_cvt_pk_bf16_f32 v12, v124, v125
    v_cvt_pk_bf16_f32 v13, v126, v127
    s_mov_b32 s47, 4096
    buffer_store_dwordx2 v[12:13], v14, s[24:27], s47 offen offset:3584
    s_nop 1
    s_waitcnt vmcnt(0)
L_k_attn_kernel_done:
    s_endpgm
.globl k_oproj_kernel
.p2align 8
.type k_oproj_kernel,@function
k_oproj_kernel:
    s_cmp_ge_u32 s2, 256
    s_cbranch_scc1 L_k_oproj_kernel_done
    s_load_dwordx2 s[8:9], s[0:1], 104
    s_waitcnt lgkmcnt(0)
    s_add_u32 s12, s8, 13631488
    s_addc_u32 s13, s9, 0
    s_and_b32 s13, s13, 0xffff
    s_mov_b32 s14, 4194304
    s_mov_b32 s15, 0x00020000
    s_add_u32 s20, s8, 42991616
    s_addc_u32 s21, s9, 0
    s_and_b32 s21, s21, 0xffff
    s_mov_b32 s22, 16777216
    s_mov_b32 s23, 0x00020000
    s_add_u32 s24, s8, 59768832
    s_addc_u32 s25, s9, 0
    s_and_b32 s25, s25, 0xffff
    s_mov_b32 s26, 16777216
    s_mov_b32 s27, 0x00020000
    s_and_b32 s28, s2, 15
    s_lshr_b32 s29, s2, 4
    s_mul_hi_u32 s30, s29, 1073741824
    s_mul_i32 s31, s30, 4
    s_sub_u32 s29, s29, s31
    v_lshrrev_b32 v1, 6, v0
    v_and_b32 v2, 63, v0
    s_nop 0
    v_readfirstlane_b32 s32, v1
    s_lshl_b32 s33, s29, 2
    s_add_u32 s33, s33, s32
    s_mul_i32 s33, s33, 262144
    s_mul_i32 s34, s30, 65536
    s_add_u32 s33, s33, s34
    s_lshl_b32 s35, s28, 2
    s_add_u32 s35, s35, s32
    s_mul_i32 s35, s35, 262144
    s_add_u32 s35, s35, s34
    v_lshlrev_b32 v3, 4, v2
    v_add_u32 v4, s33, v3
    v_add_u32 v5, s35, v3
    s_lshl_b32 s36, s32, 12
    v_mov_b32 v64, 0
    v_mov_b32 v65, 0
    v_mov_b32 v66, 0
    v_mov_b32 v67, 0
    v_mov_b32 v68, 0
    v_mov_b32 v69, 0
    v_mov_b32 v70, 0
    v_mov_b32 v71, 0
    v_mov_b32 v72, 0
    v_mov_b32 v73, 0
    v_mov_b32 v74, 0
    v_mov_b32 v75, 0
    v_mov_b32 v76, 0
    v_mov_b32 v77, 0
    v_mov_b32 v78, 0
    v_mov_b32 v79, 0
    v_mov_b32 v80, 0
    v_mov_b32 v81, 0
    v_mov_b32 v82, 0
    v_mov_b32 v83, 0
    v_mov_b32 v84, 0
    v_mov_b32 v85, 0
    v_mov_b32 v86, 0
    v_mov_b32 v87, 0
    v_mov_b32 v88, 0
    v_mov_b32 v89, 0
    v_mov_b32 v90, 0
    v_mov_b32 v91, 0
    v_mov_b32 v92, 0
    v_mov_b32 v93, 0
    v_mov_b32 v94, 0
    v_mov_b32 v95, 0
    v_mov_b32 v96, 0
    v_mov_b32 v97, 0
    v_mov_b32 v98, 0
    v_mov_b32 v99, 0
    v_mov_b32 v100, 0
    v_mov_b32 v101, 0
    v_mov_b32 v102, 0
    v_mov_b32 v103, 0
    v_mov_b32 v104, 0
    v_mov_b32 v105, 0
    v_mov_b32 v106, 0
    v_mov_b32 v107, 0
    v_mov_b32 v108, 0
    v_mov_b32 v109, 0
    v_mov_b32 v110, 0
    v_mov_b32 v111, 0
    v_mov_b32 v112, 0
    v_mov_b32 v113, 0
    v_mov_b32 v114, 0
    v_mov_b32 v115, 0
    v_mov_b32 v116, 0
    v_mov_b32 v117, 0
    v_mov_b32 v118, 0
    v_mov_b32 v119, 0
    v_mov_b32 v120, 0
    v_mov_b32 v121, 0
    v_mov_b32 v122, 0
    v_mov_b32 v123, 0
    v_mov_b32 v124, 0
    v_mov_b32 v125, 0
    v_mov_b32 v126, 0
    v_mov_b32 v127, 0
    v_and_b32 v6, 1, v1
    v_lshlrev_b32 v6, 13, v6
    v_add_u32 v6, v6, v3
    v_lshrrev_b32 v7, 1, v1
    v_lshlrev_b32 v7, 13, v7
    v_add_u32 v7, v7, v3
    v_add_u32 v7, 16384, v7
    s_mov_b32 s40, 0
    s_mov_b32 s42, 0
    s_add_u32 m0, s40, s36
    s_nop 0
    buffer_load_dwordx4 v4, s[12:15], s42 offen offset:0 lds
    buffer_load_dwordx4 v4, s[12:15], s42 offen offset:1024 lds
    buffer_load_dwordx4 v4, s[12:15], s42 offen offset:2048 lds
    buffer_load_dwordx4 v4, s[12:15], s42 offen offset:3072 lds
    s_add_u32 s41, s40, 16384
    s_add_u32 m0, s41, s36
    s_nop 0
    buffer_load_dwordx4 v5, s[20:23], s42 offen offset:0 lds
    buffer_load_dwordx4 v5, s[20:23], s42 offen offset:1024 lds
    buffer_load_dwordx4 v5, s[20:23], s42 offen offset:2048 lds
    buffer_load_dwordx4 v5, s[20:23], s42 offen offset:3072 lds
    s_mov_b32 s43, 0
L_k_oproj_kernel_loop:
    s_waitcnt vmcnt(0)
    s_barrier
    s_add_u32 s44, s43, 1
    s_cmp_lt_u32 s44, 16
    s_cbranch_scc0 L_k_oproj_kernel_nodma
    s_xor_b32 s40, s40, 32768
    s_add_u32 s42, s42, 4096
    s_add_u32 m0, s40, s36
    s_nop 0
    buffer_load_dwordx4 v4, s[12:15], s42 offen offset:0 lds
    buffer_load_dwordx4 v4, s[12:15], s42 offen offset:1024 lds
    buffer_load_dwordx4 v4, s[12:15], s42 offen offset:2048 lds
    buffer_load_dwordx4 v4, s[12:15], s42 offen offset:3072 lds
    s_add_u32 s41, s40, 16384
    s_add_u32 m0, s41, s36
    s_nop 0
    buffer_load_dwordx4 v5, s[20:23], s42 offen offset:0 lds
    buffer_load_dwordx4 v5, s[20:23], s42 offen offset:1024 lds
    buffer_load_dwordx4 v5, s[20:23], s42 offen offset:2048 lds
    buffer_load_dwordx4 v5, s[20:23], s42 offen offset:3072 lds
    s_xor_b32 s40, s40, 32768
L_k_oproj_kernel_nodma:
    v_add_u32 v8, s40, v6
    v_add_u32 v9, s40, v7
    ds_read_b128 v[16:19], v8 offset:0
    ds_read_b128 v[20:23], v8 offset:4096
    ds_read_b128 v[24:27], v9 offset:0
    ds_read_b128 v[28:31], v9 offset:4096
    ds_read_b128 v[32:35], v8 offset:1024
    ds_read_b128 v[36:39], v8 offset:5120
    ds_read_b128 v[40:43], v9 offset:1024
    ds_read_b128 v[44:47], v9 offset:5120
    s_waitcnt lgkmcnt(4)
    v_mfma_f32_32x32x16_bf16 v[64:79], v[16:19], v[24:27], v[64:79]
    v_mfma_f32_32x32x16_bf16 v[80:95], v[16:19], v[28:31], v[80:95]
    v_mfma_f32_32x32x16_bf16 v[96:111], v[20:23], v[24:27], v[96:111]
    v_mfma_f32_32x32x16_bf16 v[112:127], v[20:23], v[28:31], v[112:127]
    ds_read_b128 v[16:19], v8 offset:2048
    ds_read_b128 v[20:23], v8 offset:6144
    ds_read_b128 v[24:27], v9 offset:2048
    ds_read_b128 v[28:31], v9 offset:6144
    s_waitcnt lgkmcnt(4)
    v_mfma_f32_32x32x16_bf16 v[64:79], v[32:35], v[40:43], v[64:79]
    v_mfma_f32_32x32x16_bf16 v[80:95], v[32:35], v[44:47], v[80:95]
    v_mfma_f32_32x32x16_bf16 v[96:111], v[36:39], v[40:43], v[96:111]
    v_mfma_f32_32x32x16_bf16 v[112:127], v[36:39], v[44:47], v[112:127]
    ds_read_b128 v[32:35], v8 offset:3072
    ds_read_b128 v[36:39], v8 offset:7168
    ds_read_b128 v[40:43], v9 offset:3072
    ds_read_b128 v[44:47], v9 offset:7168
    s_waitcnt lgkmcnt(4)
    v_mfma_f32_32x32x16_bf16 v[64:79], v[16:19], v[24:27], v[64:79]
    v_mfma_f32_32x32x16_bf16 v[80:95], v[16:19], v[28:31], v[80:95]
    v_mfma_f32_32x32x16_bf16 v[96:111], v[20:23], v[24:27], v[96:111]
    v_mfma_f32_32x32x16_bf16 v[112:127], v[20:23], v[28:31], v[112:127]
    s_waitcnt lgkmcnt(0)
    v_mfma_f32_32x32x16_bf16 v[64:79], v[32:35], v[40:43], v[64:79]
    v_mfma_f32_32x32x16_bf16 v[80:95], v[32:35], v[44:47], v[80:95]
    v_mfma_f32_32x32x16_bf16 v[96:111], v[36:39], v[40:43], v[96:111]
    v_mfma_f32_32x32x16_bf16 v[112:127], v[36:39], v[44:47], v[112:127]
    s_xor_b32 s40, s40, 32768
    s_add_u32 s43, s43, 1
    s_cmp_lt_u32 s43, 16
    s_cbranch_scc1 L_k_oproj_kernel_loop
    s_nop 15
    s_nop 3
    v_and_b32 v10, 31, v2
    v_lshrrev_b32 v11, 5, v2
    s_lshl_b32 s45, s28, 7
    s_lshr_b32 s46, s32, 1
    s_lshl_b32 s46, s46, 6
    s_add_u32 s45, s45, s46
    s_mul_i32 s47, s30, 2048
    s_add_u32 s45, s45, s47
    v_add_u32 v14, s45, v10
    s_mov_b32 s47, 2048
    v_mul_lo_u32 v14, v14, s47
    s_lshl_b32 s45, s29, 7
    s_and_b32 s46, s32, 1
    s_lshl_b32 s46, s46, 6
    s_add_u32 s45, s45, s46
    s_lshl_b32 s45, s45, 2
    v_add_u32 v14, s45, v14
    v_lshl_add_u32 v14, v11, 4, v14
    buffer_store_dwordx4 v[64:67], v14, s[24:27], 0 offen offset:0
    buffer_store_dwordx4 v[68:71], v14, s[24:27], 0 offen offset:32
    buffer_store_dwordx4 v[72:75], v14, s[24:27], 0 offen offset:64
    buffer_store_dwordx4 v[76:79], v14, s[24:27], 0 offen offset:96
    s_mov_b32 s47, 65536
    buffer_store_dwordx4 v[80:83], v14, s[24:27], s47 offen
    s_mov_b32 s47, 65568
    buffer_store_dwordx4 v[84:87], v14, s[24:27], s47 offen
    s_mov_b32 s47, 65600
    buffer_store_dwordx4 v[88:91], v14, s[24:27], s47 offen
    s_mov_b32 s47, 65632
    buffer_store_dwordx4 v[92:95], v14, s[24:27], s47 offen
    buffer_store_dwordx4 v[96:99], v14, s[24:27], 0 offen offset:128
    buffer_store_dwordx4 v[100:103], v14, s[24:27], 0 offen offset:160
    buffer_store_dwordx4 v[104:107], v14, s[24:27], 0 offen offset:192
    buffer_store_dwordx4 v[108:111], v14, s[24:27], 0 offen offset:224
    s_mov_b32 s47, 65664
    buffer_store_dwordx4 v[112:115], v14, s[24:27], s47 offen
    s_mov_b32 s47, 65696
    buffer_store_dwordx4 v[116:119], v14, s[24:27], s47 offen
    s_mov_b32 s47, 65728
    buffer_store_dwordx4 v[120:123], v14, s[24:27], s47 offen
    s_mov_b32 s47, 65760
    buffer_store_dwordx4 v[124:127], v14, s[24:27], s47 offen
    s_waitcnt vmcnt(0)
L_k_oproj_kernel_done:
    s_endpgm
.globl k_ln2_kernel
.p2align 8
.type k_ln2_kernel,@function
k_ln2_kernel:
    s_cmp_ge_u32 s2, 512
    s_cbranch_scc1 L_k_ln2_kernel_done
    s_load_dwordx2 s[4:5], s[0:1], 0
    s_load_dwordx2 s[8:9], s[0:1], 104
    s_waitcnt lgkmcnt(0)
    s_mov_b32 s12, s4
    s_and_b32 s13, s5, 0xffff
    s_mov_b32 s14, 2097152
    s_mov_b32 s15, 0x00020000
    s_add_u32 s16, s8, 0
    s_addc_u32 s17, s9, 0
    s_and_b32 s17, s17, 0xffff
    s_mov_b32 s18, 12288
    s_mov_b32 s19, 0x00020000
    s_add_u32 s20, s8, 80740352
    s_addc_u32 s21, s9, 0
    s_and_b32 s21, s21, 0xffff
    s_mov_b32 s22, 2097152
    s_mov_b32 s23, 0x00020000
    s_add_u32 s24, s8, 59768832
    s_addc_u32 s25, s9, 0
    s_and_b32 s25, s25, 0xffff
    s_mov_b32 s26, 16777216
    s_mov_b32 s27, 0x00020000
    s_add_u32 s28, s8, 76546048
    s_addc_u32 s29, s9, 0
    s_and_b32 s29, s29, 0xffff
    s_mov_b32 s30, 4194304
    s_mov_b32 s31, 0x00020000
    v_lshrrev_b32 v1, 6, v0
    s_lshl_b32 s3, s2, 2
    v_add_u32 v1, s3, v1
    v_and_b32 v2, 63, v0
    v_lshlrev_b32 v3, 10, v1
    v_lshl_add_u32 v3, v2, 4, v3
    buffer_load_dwordx4 v[8:11], v3, s[12:15], 0 offen
    v_lshlrev_b32 v4, 5, v2
    v_add_u32 v5, 6144, v4
    buffer_load_dwordx4 v[12:15], v5, s[16:19], 0 offen
    buffer_load_dwordx4 v[16:19], v5, s[16:19], 0 offen offset:16
    v_add_u32 v5, 8192, v4
    buffer_load_dwordx4 v[20:23], v5, s[16:19], 0 offen
    buffer_load_dwordx4 v[24:27], v5, s[16:19], 0 offen offset:16
    v_add_u32 v5, 4096, v4
    buffer_load_dwordx4 v[28:31], v5, s[16:19], 0 offen
    buffer_load_dwordx4 v[32:35], v5, s[16:19], 0 offen offset:16
    v_lshlrev_b32 v6, 11, v1
    v_add_u32 v6, v6, v4
    s_mov_b32 s33, 0
    buffer_load_dwordx4 v[48:51], v6, s[24:27], s33 offen
    buffer_load_dwordx4 v[52:55], v6, s[24:27], s33 offen offset:16
    s_mov_b32 s33, 4194304
    buffer_load_dwordx4 v[56:59], v6, s[24:27], s33 offen
    buffer_load_dwordx4 v[60:63], v6, s[24:27], s33 offen offset:16
    s_mov_b32 s33, 8388608
    buffer_load_dwordx4 v[64:67], v6, s[24:27], s33 offen
    buffer_load_dwordx4 v[68:71], v6, s[24:27], s33 offen offset:16
    s_mov_b32 s33, 12582912
    buffer_load_dwordx4 v[72:75], v6, s[24:27], s33 offen
    buffer_load_dwordx4 v[76:79], v6, s[24:27], s33 offen offset:16
    s_waitcnt vmcnt(0)
    v_lshlrev_b32 v40, 16, v8
    v_and_b32 v41, 0xffff0000, v8
    v_lshlrev_b32 v42, 16, v9
    v_and_b32 v43, 0xffff0000, v9
    v_lshlrev_b32 v44, 16, v10
    v_and_b32 v45, 0xffff0000, v10
    v_lshlrev_b32 v46, 16, v11
    v_and_b32 v47, 0xffff0000, v11
    v_add_f32 v48, v48, v56
    v_add_f32 v64, v64, v72
    v_add_f32 v48, v48, v64
    v_fmac_f32 v40, v48, v28
    v_add_f32 v49, v49, v57
    v_add_f32 v65, v65, v73
    v_add_f32 v49, v49, v65
    v_fmac_f32 v41, v49, v29
    v_add_f32 v50, v50, v58
    v_add_f32 v66, v66, v74
    v_add_f32 v50, v50, v66
    v_fmac_f32 v42, v50, v30
    v_add_f32 v51, v51, v59
    v_add_f32 v67, v67, v75
    v_add_f32 v51, v51, v67
    v_fmac_f32 v43, v51, v31
    v_add_f32 v52, v52, v60
    v_add_f32 v68, v68, v76
    v_add_f32 v52, v52, v68
    v_fmac_f32 v44, v52, v32
    v_add_f32 v53, v53, v61
    v_add_f32 v69, v69, v77
    v_add_f32 v53, v53, v69
    v_fmac_f32 v45, v53, v33
    v_add_f32 v54, v54, v62
    v_add_f32 v70, v70, v78
    v_add_f32 v54, v54, v70
    v_fmac_f32 v46, v54, v34
    v_add_f32 v55, v55, v63
    v_add_f32 v71, v71, v79
    v_add_f32 v55, v55, v71
    v_fmac_f32 v47, v55, v35
    v_cvt_pk_bf16_f32 v36, v40, v41
    v_lshlrev_b32 v40, 16, v36
    v_and_b32 v41, 0xffff0000, v36
    v_cvt_pk_bf16_f32 v36, v42, v43
    v_lshlrev_b32 v42, 16, v36
    v_and_b32 v43, 0xffff0000, v36
    v_cvt_pk_bf16_f32 v36, v44, v45
    v_lshlrev_b32 v44, 16, v36
    v_and_b32 v45, 0xffff0000, v36
    v_cvt_pk_bf16_f32 v36, v46, v47
    v_lshlrev_b32 v46, 16, v36
    v_and_b32 v47, 0xffff0000, v36
    buffer_store_dwordx4 v[40:43], v6, s[28:31], 0 offen
    buffer_store_dwordx4 v[44:47], v6, s[28:31], 0 offen offset:16
    v_add_f32 v36, v40, v41
    v_add_f32 v36, v36, v42
    v_add_f32 v36, v36, v43
    v_add_f32 v36, v36, v44
    v_add_f32 v36, v36, v45
    v_add_f32 v36, v36, v46
    v_add_f32 v36, v36, v47
    ds_swizzle_b32 v37, v36 offset:1055
    s_waitcnt lgkmcnt(0)
    v_add_f32 v36, v36, v37
    ds_swizzle_b32 v37, v36 offset:2079
    s_waitcnt lgkmcnt(0)
    v_add_f32 v36, v36, v37
    ds_swizzle_b32 v37, v36 offset:4127
    s_waitcnt lgkmcnt(0)
    v_add_f32 v36, v36, v37
    ds_swizzle_b32 v37, v36 offset:8223
    s_waitcnt lgkmcnt(0)
    v_add_f32 v36, v36, v37
    ds_swizzle_b32 v37, v36 offset:16415
    s_waitcnt lgkmcnt(0)
    v_add_f32 v36, v36, v37
    v_mov_b32 v37, v36
    s_nop 1
    v_permlane32_swap_b32 v36, v37
    v_add_f32 v36, v36, v37
    v_mul_f32 v36, 0x3b000000, v36
    v_sub_f32 v40, v40, v36
    v_sub_f32 v41, v41, v36
    v_sub_f32 v42, v42, v36
    v_sub_f32 v43, v43, v36
    v_sub_f32 v44, v44, v36
    v_sub_f32 v45, v45, v36
    v_sub_f32 v46, v46, v36
    v_sub_f32 v47, v47, v36
    v_mul_f32 v38, v40, v40
    v_fmac_f32 v38, v41, v41
    v_fmac_f32 v38, v42, v42
    v_fmac_f32 v38, v43, v43
    v_fmac_f32 v38, v44, v44
    v_fmac_f32 v38, v45, v45
    v_fmac_f32 v38, v46, v46
    v_fmac_f32 v38, v47, v47
    ds_swizzle_b32 v37, v38 offset:1055
    s_waitcnt lgkmcnt(0)
    v_add_f32 v38, v38, v37
    ds_swizzle_b32 v37, v38 offset:2079
    s_waitcnt lgkmcnt(0)
    v_add_f32 v38, v38, v37
    ds_swizzle_b32 v37, v38 offset:4127
    s_waitcnt lgkmcnt(0)
    v_add_f32 v38, v38, v37
    ds_swizzle_b32 v37, v38 offset:8223
    s_waitcnt lgkmcnt(0)
    v_add_f32 v38, v38, v37
    ds_swizzle_b32 v37, v38 offset:16415
    s_waitcnt lgkmcnt(0)
    v_add_f32 v38, v38, v37
    v_mov_b32 v37, v38
    s_nop 1
    v_permlane32_swap_b32 v38, v37
    v_add_f32 v38, v38, v37
    v_mov_b32 v39, 0x3727c5ac
    v_fmac_f32 v39, 0x3b000000, v38
    v_rsq_f32 v39, v39
    s_nop 0
    v_mul_f32 v40, v40, v39
    v_add_f32 v20, 1.0, v20
    v_fma_f32 v40, v40, v20, v12
    v_mul_f32 v41, v41, v39
    v_add_f32 v21, 1.0, v21
    v_fma_f32 v41, v41, v21, v13
    v_mul_f32 v42, v42, v39
    v_add_f32 v22, 1.0, v22
    v_fma_f32 v42, v42, v22, v14
    v_mul_f32 v43, v43, v39
    v_add_f32 v23, 1.0, v23
    v_fma_f32 v43, v43, v23, v15
    v_mul_f32 v44, v44, v39
    v_add_f32 v24, 1.0, v24
    v_fma_f32 v44, v44, v24, v16
    v_mul_f32 v45, v45, v39
    v_add_f32 v25, 1.0, v25
    v_fma_f32 v45, v45, v25, v17
    v_mul_f32 v46, v46, v39
    v_add_f32 v26, 1.0, v26
    v_fma_f32 v46, v46, v26, v18
    v_mul_f32 v47, v47, v39
    v_add_f32 v27, 1.0, v27
    v_fma_f32 v47, v47, v27, v19
    v_cvt_pk_bf16_f32 v8, v40, v41
    v_cvt_pk_bf16_f32 v9, v42, v43
    v_cvt_pk_bf16_f32 v10, v44, v45
    v_cvt_pk_bf16_f32 v11, v46, v47
    v_lshrrev_b32 v3, 5, v1
    v_lshlrev_b32 v3, 5, v3
    v_lshrrev_b32 v4, 1, v2
    v_add_u32 v3, v3, v4
    v_lshlrev_b32 v3, 6, v3
    v_and_b32 v4, 31, v1
    v_add_u32 v3, v3, v4
    v_and_b32 v4, 1, v2
    v_lshl_add_u32 v3, v4, 5, v3
    v_lshlrev_b32 v3, 4, v3
    buffer_store_dwordx4 v[8:11], v3, s[20:23], 0 offen
    s_waitcnt vmcnt(0)
L_k_ln2_kernel_done:
    s_endpgm
.globl k_ffn1_kernel
.p2align 8
.type k_ffn1_kernel,@function
k_ffn1_kernel:
    s_cmp_ge_u32 s2, 448
    s_cbranch_scc1 L_k_ffn1_kernel_done
    s_load_dwordx2 s[8:9], s[0:1], 104
    s_waitcnt lgkmcnt(0)
    s_add_u32 s12, s8, 17825792
    s_addc_u32 s13, s9, 0
    s_and_b32 s13, s13, 0xffff
    s_mov_b32 s14, 1835008
    s_mov_b32 s15, 0x00020000
    s_add_u32 s16, s8, 19922944
    s_addc_u32 s17, s9, 0
    s_and_b32 s17, s17, 0xffff
    s_mov_b32 s18, 1835008
    s_mov_b32 s19, 0x00020000
    s_add_u32 s20, s8, 80740352
    s_addc_u32 s21, s9, 0
    s_and_b32 s21, s21, 0xffff
    s_mov_b32 s22, 2097152
    s_mov_b32 s23, 0x00020000
    s_add_u32 s24, s8, 82837504
    s_addc_u32 s25, s9, 0
    s_and_b32 s25, s25, 0xffff
    s_mov_b32 s26, 7340032
    s_mov_b32 s27, 0x00020000
    s_and_b32 s28, s2, 15
    s_lshr_b32 s29, s2, 4
    s_mul_hi_u32 s30, s29, 153391690
    s_mul_i32 s31, s30, 28
    s_sub_u32 s29, s29, s31
    v_lshrrev_b32 v1, 6, v0
    v_and_b32 v2, 63, v0
    s_nop 0
    v_readfirstlane_b32 s32, v1
    s_lshr_b32 s33, s32, 1
    s_lshl_b32 s34, s29, 1
    s_add_u32 s33, s33, s34
    s_mul_i32 s33, s33, 32768
    s_mul_i32 s34, s30, 32768
    s_add_u32 s33, s33, s34
    s_lshl_b32 s35, s28, 2
    s_add_u32 s35, s35, s32
    s_mul_i32 s35, s35, 32768
    s_add_u32 s35, s35, s34
    v_lshlrev_b32 v3, 4, v2
    v_add_u32 v4, s33, v3
    v_add_u32 v5, s35, v3
    s_lshl_b32 s36, s32, 12
    s_and_b32 s37, s32, 1
    v_mov_b32 v64, 0
    v_mov_b32 v65, 0
    v_mov_b32 v66, 0
    v_mov_b32 v67, 0
    v_mov_b32 v68, 0
    v_mov_b32 v69, 0
    v_mov_b32 v70, 0
    v_mov_b32 v71, 0
    v_mov_b32 v72, 0
    v_mov_b32 v73, 0
    v_mov_b32 v74, 0
    v_mov_b32 v75, 0
    v_mov_b32 v76, 0
    v_mov_b32 v77, 0
    v_mov_b32 v78, 0
    v_mov_b32 v79, 0
    v_mov_b32 v80, 0
    v_mov_b32 v81, 0
    v_mov_b32 v82, 0
    v_mov_b32 v83, 0
    v_mov_b32 v84, 0
    v_mov_b32 v85, 0
    v_mov_b32 v86, 0
    v_mov_b32 v87, 0
    v_mov_b32 v88, 0
    v_mov_b32 v89, 0
    v_mov_b32 v90, 0
    v_mov_b32 v91, 0
    v_mov_b32 v92, 0
    v_mov_b32 v93, 0
    v_mov_b32 v94, 0
    v_mov_b32 v95, 0
    v_mov_b32 v96, 0
    v_mov_b32 v97, 0
    v_mov_b32 v98, 0
    v_mov_b32 v99, 0
    v_mov_b32 v100, 0
    v_mov_b32 v101, 0
    v_mov_b32 v102, 0
    v_mov_b32 v103, 0
    v_mov_b32 v104, 0
    v_mov_b32 v105, 0
    v_mov_b32 v106, 0
    v_mov_b32 v107, 0
    v_mov_b32 v108, 0
    v_mov_b32 v109, 0
    v_mov_b32 v110, 0
    v_mov_b32 v111, 0
    v_mov_b32 v112, 0
    v_mov_b32 v113, 0
    v_mov_b32 v114, 0
    v_mov_b32 v115, 0
    v_mov_b32 v116, 0
    v_mov_b32 v117, 0
    v_mov_b32 v118, 0
    v_mov_b32 v119, 0
    v_mov_b32 v120, 0
    v_mov_b32 v121, 0
    v_mov_b32 v122, 0
    v_mov_b32 v123, 0
    v_mov_b32 v124, 0
    v_mov_b32 v125, 0
    v_mov_b32 v126, 0
    v_mov_b32 v127, 0
    v_and_b32 v6, 1, v1
    v_lshlrev_b32 v6, 13, v6
    v_add_u32 v6, v6, v3
    v_lshrrev_b32 v7, 1, v1
    v_lshlrev_b32 v7, 13, v7
    v_add_u32 v7, v7, v3
    v_add_u32 v7, 16384, v7
    s_mov_b32 s40, 0
    s_mov_b32 s42, 0
    s_add_u32 m0, s40, s36
    s_nop 0
    s_cmp_eq_u32 s37, 0
    s_cbranch_scc0 L_k_ffn1_kernel_up1
    buffer_load_dwordx4 v4, s[12:15], s42 offen offset:0 lds
    buffer_load_dwordx4 v4, s[12:15], s42 offen offset:1024 lds
    buffer_load_dwordx4 v4, s[12:15], s42 offen offset:2048 lds
    buffer_load_dwordx4 v4, s[12:15], s42 offen offset:3072 lds
    s_branch L_k_ffn1_kernel_join1
L_k_ffn1_kernel_up1:
    buffer_load_dwordx4 v4, s[16:19], s42 offen offset:0 lds
    buffer_load_dwordx4 v4, s[16:19], s42 offen offset:1024 lds
    buffer_load_dwordx4 v4, s[16:19], s42 offen offset:2048 lds
    buffer_load_dwordx4 v4, s[16:19], s42 offen offset:3072 lds
L_k_ffn1_kernel_join1:
    s_add_u32 s41, s40, 16384
    s_add_u32 m0, s41, s36
    s_nop 0
    buffer_load_dwordx4 v5, s[20:23], s42 offen offset:0 lds
    buffer_load_dwordx4 v5, s[20:23], s42 offen offset:1024 lds
    buffer_load_dwordx4 v5, s[20:23], s42 offen offset:2048 lds
    buffer_load_dwordx4 v5, s[20:23], s42 offen offset:3072 lds
    s_mov_b32 s43, 0
L_k_ffn1_kernel_loop:
    s_waitcnt vmcnt(0)
    s_barrier
    s_add_u32 s44, s43, 1
    s_cmp_lt_u32 s44, 8
    s_cbranch_scc0 L_k_ffn1_kernel_nodma
    s_xor_b32 s40, s40, 32768
    s_add_u32 s42, s42, 4096
    s_add_u32 m0, s40, s36
    s_nop 0
    s_cmp_eq_u32 s37, 0
    s_cbranch_scc0 L_k_ffn1_kernel_up2
    buffer_load_dwordx4 v4, s[12:15], s42 offen offset:0 lds
    buffer_load_dwordx4 v4, s[12:15], s42 offen offset:1024 lds
    buffer_load_dwordx4 v4, s[12:15], s42 offen offset:2048 lds
    buffer_load_dwordx4 v4, s[12:15], s42 offen offset:3072 lds
    s_branch L_k_ffn1_kernel_join2
L_k_ffn1_kernel_up2:
    buffer_load_dwordx4 v4, s[16:19], s42 offen offset:0 lds
    buffer_load_dwordx4 v4, s[16:19], s42 offen offset:1024 lds
    buffer_load_dwordx4 v4, s[16:19], s42 offen offset:2048 lds
    buffer_load_dwordx4 v4, s[16:19], s42 offen offset:3072 lds
L_k_ffn1_kernel_join2:
    s_add_u32 s41, s40, 16384
    s_add_u32 m0, s41, s36
    s_nop 0
    buffer_load_dwordx4 v5, s[20:23], s42 offen offset:0 lds
    buffer_load_dwordx4 v5, s[20:23], s42 offen offset:1024 lds
    buffer_load_dwordx4 v5, s[20:23], s42 offen offset:2048 lds
    buffer_load_dwordx4 v5, s[20:23], s42 offen offset:3072 lds
    s_xor_b32 s40, s40, 32768
L_k_ffn1_kernel_nodma:
    v_add_u32 v8, s40, v6
    v_add_u32 v9, s40, v7
    ds_read_b128 v[16:19], v8 offset:0
    ds_read_b128 v[20:23], v8 offset:4096
    ds_read_b128 v[24:27], v9 offset:0
    ds_read_b128 v[28:31], v9 offset:4096
    ds_read_b128 v[32:35], v8 offset:1024
    ds_read_b128 v[36:39], v8 offset:5120
    ds_read_b128 v[40:43], v9 offset:1024
    ds_read_b128 v[44:47], v9 offset:5120
    s_waitcnt lgkmcnt(4)
    v_mfma_f32_32x32x16_bf16 v[64:79], v[16:19], v[24:27], v[64:79]
    v_mfma_f32_32x32x16_bf16 v[80:95], v[16:19], v[28:31], v[80:95]
    v_mfma_f32_32x32x16_bf16 v[96:111], v[20:23], v[24:27], v[96:111]
    v_mfma_f32_32x32x16_bf16 v[112:127], v[20:23], v[28:31], v[112:127]
    ds_read_b128 v[16:19], v8 offset:2048
    ds_read_b128 v[20:23], v8 offset:6144
    ds_read_b128 v[24:27], v9 offset:2048
    ds_read_b128 v[28:31], v9 offset:6144
    s_waitcnt lgkmcnt(4)
    v_mfma_f32_32x32x16_bf16 v[64:79], v[32:35], v[40:43], v[64:79]
    v_mfma_f32_32x32x16_bf16 v[80:95], v[32:35], v[44:47], v[80:95]
    v_mfma_f32_32x32x16_bf16 v[96:111], v[36:39], v[40:43], v[96:111]
    v_mfma_f32_32x32x16_bf16 v[112:127], v[36:39], v[44:47], v[112:127]
    ds_read_b128 v[32:35], v8 offset:3072
    ds_read_b128 v[36:39], v8 offset:7168
    ds_read_b128 v[40:43], v9 offset:3072
    ds_read_b128 v[44:47], v9 offset:7168
    s_waitcnt lgkmcnt(4)
    v_mfma_f32_32x32x16_bf16 v[64:79], v[16:19], v[24:27], v[64:79]
    v_mfma_f32_32x32x16_bf16 v[80:95], v[16:19], v[28:31], v[80:95]
    v_mfma_f32_32x32x16_bf16 v[96:111], v[20:23], v[24:27], v[96:111]
    v_mfma_f32_32x32x16_bf16 v[112:127], v[20:23], v[28:31], v[112:127]
    s_waitcnt lgkmcnt(0)
    v_mfma_f32_32x32x16_bf16 v[64:79], v[32:35], v[40:43], v[64:79]
    v_mfma_f32_32x32x16_bf16 v[80:95], v[32:35], v[44:47], v[80:95]
    v_mfma_f32_32x32x16_bf16 v[96:111], v[36:39], v[40:43], v[96:111]
    v_mfma_f32_32x32x16_bf16 v[112:127], v[36:39], v[44:47], v[112:127]
    s_xor_b32 s40, s40, 32768
    s_add_u32 s43, s43, 1
    s_cmp_lt_u32 s43, 8
    s_cbranch_scc1 L_k_ffn1_kernel_loop
    s_nop 15
    s_nop 3
    v_and_b32 v10, 31, v2
    v_lshrrev_b32 v11, 5, v2
    v_mul_f32 v12, v64, v64
    v_mov_b32 v13, 0x3d372713
    v_fma_f32 v12, v12, v13, 1.0
    v_mul_f32 v12, v12, v64
    v_mul_f32 v12, 0xc0135761, v12
    v_exp_f32 v12, v12
    s_nop 0
    v_add_f32 v12, 1.0, v12
    v_rcp_f32 v12, v12
    s_nop 0
    v_mul_f32 v12, v12, v64
    v_mul_f32 v64, v12, v96
    v_mul_f32 v12, v65, v65
    v_mov_b32 v13, 0x3d372713
    v_fma_f32 v12, v12, v13, 1.0
    v_mul_f32 v12, v12, v65
    v_mul_f32 v12, 0xc0135761, v12
    v_exp_f32 v12, v12
    s_nop 0
    v_add_f32 v12, 1.0, v12
    v_rcp_f32 v12, v12
    s_nop 0
    v_mul_f32 v12, v12, v65
    v_mul_f32 v65, v12, v97
    v_mul_f32 v12, v66, v66
    v_mov_b32 v13, 0x3d372713
    v_fma_f32 v12, v12, v13, 1.0
    v_mul_f32 v12, v12, v66
    v_mul_f32 v12, 0xc0135761, v12
    v_exp_f32 v12, v12
    s_nop 0
    v_add_f32 v12, 1.0, v12
    v_rcp_f32 v12, v12
    s_nop 0
    v_mul_f32 v12, v12, v66
    v_mul_f32 v66, v12, v98
    v_mul_f32 v12, v67, v67
    v_mov_b32 v13, 0x3d372713
    v_fma_f32 v12, v12, v13, 1.0
    v_mul_f32 v12, v12, v67
    v_mul_f32 v12, 0xc0135761, v12
    v_exp_f32 v12, v12
    s_nop 0
    v_add_f32 v12, 1.0, v12
    v_rcp_f32 v12, v12
    s_nop 0
    v_mul_f32 v12, v12, v67
    v_mul_f32 v67, v12, v99
    v_mul_f32 v12, v68, v68
    v_mov_b32 v13, 0x3d372713
    v_fma_f32 v12, v12, v13, 1.0
    v_mul_f32 v12, v12, v68
    v_mul_f32 v12, 0xc0135761, v12
    v_exp_f32 v12, v12
    s_nop 0
    v_add_f32 v12, 1.0, v12
    v_rcp_f32 v12, v12
    s_nop 0
    v_mul_f32 v12, v12, v68
    v_mul_f32 v68, v12, v100
    v_mul_f32 v12, v69, v69
    v_mov_b32 v13, 0x3d372713
    v_fma_f32 v12, v12, v13, 1.0
    v_mul_f32 v12, v12, v69
    v_mul_f32 v12, 0xc0135761, v12
    v_exp_f32 v12, v12
    s_nop 0
    v_add_f32 v12, 1.0, v12
    v_rcp_f32 v12, v12
    s_nop 0
    v_mul_f32 v12, v12, v69
    v_mul_f32 v69, v12, v101
    v_mul_f32 v12, v70, v70
    v_mov_b32 v13, 0x3d372713
    v_fma_f32 v12, v12, v13, 1.0
    v_mul_f32 v12, v12, v70
    v_mul_f32 v12, 0xc0135761, v12
    v_exp_f32 v12, v12
    s_nop 0
    v_add_f32 v12, 1.0, v12
    v_rcp_f32 v12, v12
    s_nop 0
    v_mul_f32 v12, v12, v70
    v_mul_f32 v70, v12, v102
    v_mul_f32 v12, v71, v71
    v_mov_b32 v13, 0x3d372713
    v_fma_f32 v12, v12, v13, 1.0
    v_mul_f32 v12, v12, v71
    v_mul_f32 v12, 0xc0135761, v12
    v_exp_f32 v12, v12
    s_nop 0
    v_add_f32 v12, 1.0, v12
    v_rcp_f32 v12, v12
    s_nop 0
    v_mul_f32 v12, v12, v71
    v_mul_f32 v71, v12, v103
    v_mul_f32 v12, v72, v72
    v_mov_b32 v13, 0x3d372713
    v_fma_f32 v12, v12, v13, 1.0
    v_mul_f32 v12, v12, v72
    v_mul_f32 v12, 0xc0135761, v12
    v_exp_f32 v12, v12
    s_nop 0
    v_add_f32 v12, 1.0, v12
    v_rcp_f32 v12, v12
    s_nop 0
    v_mul_f32 v12, v12, v72
    v_mul_f32 v72, v12, v104
    v_mul_f32 v12, v73, v73
    v_mov_b32 v13, 0x3d372713
    v_fma_f32 v12, v12, v13, 1.0
    v_mul_f32 v12, v12, v73
    v_mul_f32 v12, 0xc0135761, v12
    v_exp_f32 v12, v12
    s_nop 0
    v_add_f32 v12, 1.0, v12
    v_rcp_f32 v12, v12
    s_nop 0
    v_mul_f32 v12, v12, v73
    v_mul_f32 v73, v12, v105
    v_mul_f32 v12, v74, v74
    v_mov_b32 v13, 0x3d372713
    v_fma_f32 v12, v12, v13, 1.0
    v_mul_f32 v12, v12, v74
    v_mul_f32 v12, 0xc0135761, v12
    v_exp_f32 v12, v12
    s_nop 0
    v_add_f32 v12, 1.0, v12
    v_rcp_f32 v12, v12
    s_nop 0
    v_mul_f32 v12, v12, v74
    v_mul_f32 v74, v12, v106
    v_mul_f32 v12, v75, v75
    v_mov_b32 v13, 0x3d372713
    v_fma_f32 v12, v12, v13, 1.0
    v_mul_f32 v12, v12, v75
    v_mul_f32 v12, 0xc0135761, v12
    v_exp_f32 v12, v12
    s_nop 0
    v_add_f32 v12, 1.0, v12
    v_rcp_f32 v12, v12
    s_nop 0
    v_mul_f32 v12, v12, v75
    v_mul_f32 v75, v12, v107
    v_mul_f32 v12, v76, v76
    v_mov_b32 v13, 0x3d372713
    v_fma_f32 v12, v12, v13, 1.0
    v_mul_f32 v12, v12, v76
    v_mul_f32 v12, 0xc0135761, v12
    v_exp_f32 v12, v12
    s_nop 0
    v_add_f32 v12, 1.0, v12
    v_rcp_f32 v12, v12
    s_nop 0
    v_mul_f32 v12, v12, v76
    v_mul_f32 v76, v12, v108
    v_mul_f32 v12, v77, v77
    v_mov_b32 v13, 0x3d372713
    v_fma_f32 v12, v12, v13, 1.0
    v_mul_f32 v12, v12, v77
    v_mul_f32 v12, 0xc0135761, v12
    v_exp_f32 v12, v12
    s_nop 0
    v_add_f32 v12, 1.0, v12
    v_rcp_f32 v12, v12
    s_nop 0
    v_mul_f32 v12, v12, v77
    v_mul_f32 v77, v12, v109
    v_mul_f32 v12, v78, v78
    v_mov_b32 v13, 0x3d372713
    v_fma_f32 v12, v12, v13, 1.0
    v_mul_f32 v12, v12, v78
    v_mul_f32 v12, 0xc0135761, v12
    v_exp_f32 v12, v12
    s_nop 0
    v_add_f32 v12, 1.0, v12
    v_rcp_f32 v12, v12
    s_nop 0
    v_mul_f32 v12, v12, v78
    v_mul_f32 v78, v12, v110
    v_mul_f32 v12, v79, v79
    v_mov_b32 v13, 0x3d372713
    v_fma_f32 v12, v12, v13, 1.0
    v_mul_f32 v12, v12, v79
    v_mul_f32 v12, 0xc0135761, v12
    v_exp_f32 v12, v12
    s_nop 0
    v_add_f32 v12, 1.0, v12
    v_rcp_f32 v12, v12
    s_nop 0
    v_mul_f32 v12, v12, v79
    v_mul_f32 v79, v12, v111
    v_cvt_pk_bf16_f32 v12, v64, v65
    v_cvt_pk_bf16_f32 v13, v66, v67
    s_lshl_b32 s45, s28, 2
    s_lshr_b32 s46, s32, 1
    s_lshl_b32 s46, s46, 1
    s_add_u32 s45, s45, s46
    s_add_u32 s45, s45, 0
    s_mul_i32 s45, s45, 112
    s_lshl_b32 s46, s29, 2
    s_add_u32 s45, s45, s46
    s_and_b32 s46, s32, 1
    s_lshl_b32 s46, s46, 1
    s_add_u32 s45, s45, s46
    s_add_u32 s45, s45, 0
    s_lshl_b32 s45, s45, 10
    v_lshl_add_u32 v14, v10, 4, s45
    v_lshl_add_u32 v14, v11, 3, v14
    buffer_store_dwordx2 v[12:13], v14, s[24:27], 0 offen offset:0
    s_nop 1
    v_cvt_pk_bf16_f32 v12, v68, v69
    v_cvt_pk_bf16_f32 v13, v70, v71
    s_lshl_b32 s45, s28, 2
    s_lshr_b32 s46, s32, 1
    s_lshl_b32 s46, s46, 1
    s_add_u32 s45, s45, s46
    s_add_u32 s45, s45, 0
    s_mul_i32 s45, s45, 112
    s_lshl_b32 s46, s29, 2
    s_add_u32 s45, s45, s46
    s_and_b32 s46, s32, 1
    s_lshl_b32 s46, s46, 1
    s_add_u32 s45, s45, s46
    s_add_u32 s45, s45, 0
    s_lshl_b32 s45, s45, 10
    v_lshl_add_u32 v14, v10, 4, s45
    v_lshl_add_u32 v14, v11, 3, v14
    buffer_store_dwordx2 v[12:13], v14, s[24:27], 0 offen offset:512
    s_nop 1
    v_cvt_pk_bf16_f32 v12, v72, v73
    v_cvt_pk_bf16_f32 v13, v74, v75
    s_lshl_b32 s45, s28, 2
    s_lshr_b32 s46, s32, 1
    s_lshl_b32 s46, s46, 1
    s_add_u32 s45, s45, s46
    s_add_u32 s45, s45, 0
    s_mul_i32 s45, s45, 112
    s_lshl_b32 s46, s29, 2
    s_add_u32 s45, s45, s46
    s_and_b32 s46, s32, 1
    s_lshl_b32 s46, s46, 1
    s_add_u32 s45, s45, s46
    s_add_u32 s45, s45, 1
    s_lshl_b32 s45, s45, 10
    v_lshl_add_u32 v14, v10, 4, s45
    v_lshl_add_u32 v14, v11, 3, v14
    buffer_store_dwordx2 v[12:13], v14, s[24:27], 0 offen offset:0
    s_nop 1
    v_cvt_pk_bf16_f32 v12, v76, v77
    v_cvt_pk_bf16_f32 v13, v78, v79
    s_lshl_b32 s45, s28, 2
    s_lshr_b32 s46, s32, 1
    s_lshl_b32 s46, s46, 1
    s_add_u32 s45, s45, s46
    s_add_u32 s45, s45, 0
    s_mul_i32 s45, s45, 112
    s_lshl_b32 s46, s29, 2
    s_add_u32 s45, s45, s46
    s_and_b32 s46, s32, 1
    s_lshl_b32 s46, s46, 1
    s_add_u32 s45, s45, s46
    s_add_u32 s45, s45, 1
    s_lshl_b32 s45, s45, 10
    v_lshl_add_u32 v14, v10, 4, s45
    v_lshl_add_u32 v14, v11, 3, v14
    buffer_store_dwordx2 v[12:13], v14, s[24:27], 0 offen offset:512
    s_nop 1
    v_mul_f32 v12, v80, v80
    v_mov_b32 v13, 0x3d372713
    v_fma_f32 v12, v12, v13, 1.0
    v_mul_f32 v12, v12, v80
    v_mul_f32 v12, 0xc0135761, v12
    v_exp_f32 v12, v12
    s_nop 0
    v_add_f32 v12, 1.0, v12
    v_rcp_f32 v12, v12
    s_nop 0
    v_mul_f32 v12, v12, v80
    v_mul_f32 v80, v12, v112
    v_mul_f32 v12, v81, v81
    v_mov_b32 v13, 0x3d372713
    v_fma_f32 v12, v12, v13, 1.0
    v_mul_f32 v12, v12, v81
    v_mul_f32 v12, 0xc0135761, v12
    v_exp_f32 v12, v12
    s_nop 0
    v_add_f32 v12, 1.0, v12
    v_rcp_f32 v12, v12
    s_nop 0
    v_mul_f32 v12, v12, v81
    v_mul_f32 v81, v12, v113
    v_mul_f32 v12, v82, v82
    v_mov_b32 v13, 0x3d372713
    v_fma_f32 v12, v12, v13, 1.0
    v_mul_f32 v12, v12, v82
    v_mul_f32 v12, 0xc0135761, v12
    v_exp_f32 v12, v12
    s_nop 0
    v_add_f32 v12, 1.0, v12
    v_rcp_f32 v12, v12
    s_nop 0
    v_mul_f32 v12, v12, v82
    v_mul_f32 v82, v12, v114
    v_mul_f32 v12, v83, v83
    v_mov_b32 v13, 0x3d372713
    v_fma_f32 v12, v12, v13, 1.0
    v_mul_f32 v12, v12, v83
    v_mul_f32 v12, 0xc0135761, v12
    v_exp_f32 v12, v12
    s_nop 0
    v_add_f32 v12, 1.0, v12
    v_rcp_f32 v12, v12
    s_nop 0
    v_mul_f32 v12, v12, v83
    v_mul_f32 v83, v12, v115
    v_mul_f32 v12, v84, v84
    v_mov_b32 v13, 0x3d372713
    v_fma_f32 v12, v12, v13, 1.0
    v_mul_f32 v12, v12, v84
    v_mul_f32 v12, 0xc0135761, v12
    v_exp_f32 v12, v12
    s_nop 0
    v_add_f32 v12, 1.0, v12
    v_rcp_f32 v12, v12
    s_nop 0
    v_mul_f32 v12, v12, v84
    v_mul_f32 v84, v12, v116
    v_mul_f32 v12, v85, v85
    v_mov_b32 v13, 0x3d372713
    v_fma_f32 v12, v12, v13, 1.0
    v_mul_f32 v12, v12, v85
    v_mul_f32 v12, 0xc0135761, v12
    v_exp_f32 v12, v12
    s_nop 0
    v_add_f32 v12, 1.0, v12
    v_rcp_f32 v12, v12
    s_nop 0
    v_mul_f32 v12, v12, v85
    v_mul_f32 v85, v12, v117
    v_mul_f32 v12, v86, v86
    v_mov_b32 v13, 0x3d372713
    v_fma_f32 v12, v12, v13, 1.0
    v_mul_f32 v12, v12, v86
    v_mul_f32 v12, 0xc0135761, v12
    v_exp_f32 v12, v12
    s_nop 0
    v_add_f32 v12, 1.0, v12
    v_rcp_f32 v12, v12
    s_nop 0
    v_mul_f32 v12, v12, v86
    v_mul_f32 v86, v12, v118
    v_mul_f32 v12, v87, v87
    v_mov_b32 v13, 0x3d372713
    v_fma_f32 v12, v12, v13, 1.0
    v_mul_f32 v12, v12, v87
    v_mul_f32 v12, 0xc0135761, v12
    v_exp_f32 v12, v12
    s_nop 0
    v_add_f32 v12, 1.0, v12
    v_rcp_f32 v12, v12
    s_nop 0
    v_mul_f32 v12, v12, v87
    v_mul_f32 v87, v12, v119
    v_mul_f32 v12, v88, v88
    v_mov_b32 v13, 0x3d372713
    v_fma_f32 v12, v12, v13, 1.0
    v_mul_f32 v12, v12, v88
    v_mul_f32 v12, 0xc0135761, v12
    v_exp_f32 v12, v12
    s_nop 0
    v_add_f32 v12, 1.0, v12
    v_rcp_f32 v12, v12
    s_nop 0
    v_mul_f32 v12, v12, v88
    v_mul_f32 v88, v12, v120
    v_mul_f32 v12, v89, v89
    v_mov_b32 v13, 0x3d372713
    v_fma_f32 v12, v12, v13, 1.0
    v_mul_f32 v12, v12, v89
    v_mul_f32 v12, 0xc0135761, v12
    v_exp_f32 v12, v12
    s_nop 0
    v_add_f32 v12, 1.0, v12
    v_rcp_f32 v12, v12
    s_nop 0
    v_mul_f32 v12, v12, v89
    v_mul_f32 v89, v12, v121
    v_mul_f32 v12, v90, v90
    v_mov_b32 v13, 0x3d372713
    v_fma_f32 v12, v12, v13, 1.0
    v_mul_f32 v12, v12, v90
    v_mul_f32 v12, 0xc0135761, v12
    v_exp_f32 v12, v12
    s_nop 0
    v_add_f32 v12, 1.0, v12
    v_rcp_f32 v12, v12
    s_nop 0
    v_mul_f32 v12, v12, v90
    v_mul_f32 v90, v12, v122
    v_mul_f32 v12, v91, v91
    v_mov_b32 v13, 0x3d372713
    v_fma_f32 v12, v12, v13, 1.0
    v_mul_f32 v12, v12, v91
    v_mul_f32 v12, 0xc0135761, v12
    v_exp_f32 v12, v12
    s_nop 0
    v_add_f32 v12, 1.0, v12
    v_rcp_f32 v12, v12
    s_nop 0
    v_mul_f32 v12, v12, v91
    v_mul_f32 v91, v12, v123
    v_mul_f32 v12, v92, v92
    v_mov_b32 v13, 0x3d372713
    v_fma_f32 v12, v12, v13, 1.0
    v_mul_f32 v12, v12, v92
    v_mul_f32 v12, 0xc0135761, v12
    v_exp_f32 v12, v12
    s_nop 0
    v_add_f32 v12, 1.0, v12
    v_rcp_f32 v12, v12
    s_nop 0
    v_mul_f32 v12, v12, v92
    v_mul_f32 v92, v12, v124
    v_mul_f32 v12, v93, v93
    v_mov_b32 v13, 0x3d372713
    v_fma_f32 v12, v12, v13, 1.0
    v_mul_f32 v12, v12, v93
    v_mul_f32 v12, 0xc0135761, v12
    v_exp_f32 v12, v12
    s_nop 0
    v_add_f32 v12, 1.0, v12
    v_rcp_f32 v12, v12
    s_nop 0
    v_mul_f32 v12, v12, v93
    v_mul_f32 v93, v12, v125
    v_mul_f32 v12, v94, v94
    v_mov_b32 v13, 0x3d372713
    v_fma_f32 v12, v12, v13, 1.0
    v_mul_f32 v12, v12, v94
    v_mul_f32 v12, 0xc0135761, v12
    v_exp_f32 v12, v12
    s_nop 0
    v_add_f32 v12, 1.0, v12
    v_rcp_f32 v12, v12
    s_nop 0
    v_mul_f32 v12, v12, v94
    v_mul_f32 v94, v12, v126
    v_mul_f32 v12, v95, v95
    v_mov_b32 v13, 0x3d372713
    v_fma_f32 v12, v12, v13, 1.0
    v_mul_f32 v12, v12, v95
    v_mul_f32 v12, 0xc0135761, v12
    v_exp_f32 v12, v12
    s_nop 0
    v_add_f32 v12, 1.0, v12
    v_rcp_f32 v12, v12
    s_nop 0
    v_mul_f32 v12, v12, v95
    v_mul_f32 v95, v12, v127
    v_cvt_pk_bf16_f32 v12, v80, v81
    v_cvt_pk_bf16_f32 v13, v82, v83
    s_lshl_b32 s45, s28, 2
    s_lshr_b32 s46, s32, 1
    s_lshl_b32 s46, s46, 1
    s_add_u32 s45, s45, s46
    s_add_u32 s45, s45, 1
    s_mul_i32 s45, s45, 112
    s_lshl_b32 s46, s29, 2
    s_add_u32 s45, s45, s46
    s_and_b32 s46, s32, 1
    s_lshl_b32 s46, s46, 1
    s_add_u32 s45, s45, s46
    s_add_u32 s45, s45, 0
    s_lshl_b32 s45, s45, 10
    v_lshl_add_u32 v14, v10, 4, s45
    v_lshl_add_u32 v14, v11, 3, v14
    buffer_store_dwordx2 v[12:13], v14, s[24:27], 0 offen offset:0
    s_nop 1
    v_cvt_pk_bf16_f32 v12, v84, v85
    v_cvt_pk_bf16_f32 v13, v86, v87
    s_lshl_b32 s45, s28, 2
    s_lshr_b32 s46, s32, 1
    s_lshl_b32 s46, s46, 1
    s_add_u32 s45, s45, s46
    s_add_u32 s45, s45, 1
    s_mul_i32 s45, s45, 112
    s_lshl_b32 s46, s29, 2
    s_add_u32 s45, s45, s46
    s_and_b32 s46, s32, 1
    s_lshl_b32 s46, s46, 1
    s_add_u32 s45, s45, s46
    s_add_u32 s45, s45, 0
    s_lshl_b32 s45, s45, 10
    v_lshl_add_u32 v14, v10, 4, s45
    v_lshl_add_u32 v14, v11, 3, v14
    buffer_store_dwordx2 v[12:13], v14, s[24:27], 0 offen offset:512
    s_nop 1
    v_cvt_pk_bf16_f32 v12, v88, v89
    v_cvt_pk_bf16_f32 v13, v90, v91
    s_lshl_b32 s45, s28, 2
    s_lshr_b32 s46, s32, 1
    s_lshl_b32 s46, s46, 1
    s_add_u32 s45, s45, s46
    s_add_u32 s45, s45, 1
    s_mul_i32 s45, s45, 112
    s_lshl_b32 s46, s29, 2
    s_add_u32 s45, s45, s46
    s_and_b32 s46, s32, 1
    s_lshl_b32 s46, s46, 1
    s_add_u32 s45, s45, s46
    s_add_u32 s45, s45, 1
    s_lshl_b32 s45, s45, 10
    v_lshl_add_u32 v14, v10, 4, s45
    v_lshl_add_u32 v14, v11, 3, v14
    buffer_store_dwordx2 v[12:13], v14, s[24:27], 0 offen offset:0
    s_nop 1
    v_cvt_pk_bf16_f32 v12, v92, v93
    v_cvt_pk_bf16_f32 v13, v94, v95
    s_lshl_b32 s45, s28, 2
    s_lshr_b32 s46, s32, 1
    s_lshl_b32 s46, s46, 1
    s_add_u32 s45, s45, s46
    s_add_u32 s45, s45, 1
    s_mul_i32 s45, s45, 112
    s_lshl_b32 s46, s29, 2
    s_add_u32 s45, s45, s46
    s_and_b32 s46, s32, 1
    s_lshl_b32 s46, s46, 1
    s_add_u32 s45, s45, s46
    s_add_u32 s45, s45, 1
    s_lshl_b32 s45, s45, 10
    v_lshl_add_u32 v14, v10, 4, s45
    v_lshl_add_u32 v14, v11, 3, v14
    buffer_store_dwordx2 v[12:13], v14, s[24:27], 0 offen offset:512
    s_nop 1
    s_waitcnt vmcnt(0)
L_k_ffn1_kernel_done:
    s_endpgm
.globl k_ffn2_kernel
.p2align 8
.type k_ffn2_kernel,@function
k_ffn2_kernel:
    s_cmp_ge_u32 s2, 256
    s_cbranch_scc1 L_k_ffn2_kernel_done
    s_load_dwordx2 s[8:9], s[0:1], 104
    s_waitcnt lgkmcnt(0)
    s_add_u32 s12, s8, 22020096
    s_addc_u32 s13, s9, 0
    s_and_b32 s13, s13, 0xffff
    s_mov_b32 s14, 1835008
    s_mov_b32 s15, 0x00020000
    s_add_u32 s20, s8, 82837504
    s_addc_u32 s21, s9, 0
    s_and_b32 s21, s21, 0xffff
    s_mov_b32 s22, 7340032
    s_mov_b32 s23, 0x00020000
    s_add_u32 s24, s8, 91226112
    s_addc_u32 s25, s9, 0
    s_and_b32 s25, s25, 0xffff
    s_mov_b32 s26, 16777216
    s_mov_b32 s27, 0x00020000
    s_and_b32 s28, s2, 15
    s_lshr_b32 s29, s2, 4
    s_mul_hi_u32 s30, s29, 1073741824
    s_mul_i32 s31, s30, 4
    s_sub_u32 s29, s29, s31
    v_lshrrev_b32 v1, 6, v0
    v_and_b32 v2, 63, v0
    s_nop 0
    v_readfirstlane_b32 s32, v1
    s_lshl_b32 s33, s29, 2
    s_add_u32 s33, s33, s32
    s_mul_i32 s33, s33, 114688
    s_mul_i32 s34, s30, 28672
    s_add_u32 s33, s33, s34
    s_lshl_b32 s35, s28, 2
    s_add_u32 s35, s35, s32
    s_mul_i32 s35, s35, 114688
    s_add_u32 s35, s35, s34
    v_lshlrev_b32 v3, 4, v2
    v_add_u32 v4, s33, v3
    v_add_u32 v5, s35, v3
    s_lshl_b32 s36, s32, 12
    v_mov_b32 v64, 0
    v_mov_b32 v65, 0
    v_mov_b32 v66, 0
    v_mov_b32 v67, 0
    v_mov_b32 v68, 0
    v_mov_b32 v69, 0
    v_mov_b32 v70, 0
    v_mov_b32 v71, 0
    v_mov_b32 v72, 0
    v_mov_b32 v73, 0
    v_mov_b32 v74, 0
    v_mov_b32 v75, 0
    v_mov_b32 v76, 0
    v_mov_b32 v77, 0
    v_mov_b32 v78, 0
    v_mov_b32 v79, 0
    v_mov_b32 v80, 0
    v_mov_b32 v81, 0
    v_mov_b32 v82, 0
    v_mov_b32 v83, 0
    v_mov_b32 v84, 0
    v_mov_b32 v85, 0
    v_mov_b32 v86, 0
    v_mov_b32 v87, 0
    v_mov_b32 v88, 0
    v_mov_b32 v89, 0
    v_mov_b32 v90, 0
    v_mov_b32 v91, 0
    v_mov_b32 v92, 0
    v_mov_b32 v93, 0
    v_mov_b32 v94, 0
    v_mov_b32 v95, 0
    v_mov_b32 v96, 0
    v_mov_b32 v97, 0
    v_mov_b32 v98, 0
    v_mov_b32 v99, 0
    v_mov_b32 v100, 0
    v_mov_b32 v101, 0
    v_mov_b32 v102, 0
    v_mov_b32 v103, 0
    v_mov_b32 v104, 0
    v_mov_b32 v105, 0
    v_mov_b32 v106, 0
    v_mov_b32 v107, 0
    v_mov_b32 v108, 0
    v_mov_b32 v109, 0
    v_mov_b32 v110, 0
    v_mov_b32 v111, 0
    v_mov_b32 v112, 0
    v_mov_b32 v113, 0
    v_mov_b32 v114, 0
    v_mov_b32 v115, 0
    v_mov_b32 v116, 0
    v_mov_b32 v117, 0
    v_mov_b32 v118, 0
    v_mov_b32 v119, 0
    v_mov_b32 v120, 0
    v_mov_b32 v121, 0
    v_mov_b32 v122, 0
    v_mov_b32 v123, 0
    v_mov_b32 v124, 0
    v_mov_b32 v125, 0
    v_mov_b32 v126, 0
    v_mov_b32 v127, 0
    v_and_b32 v6, 1, v1
    v_lshlrev_b32 v6, 13, v6
    v_add_u32 v6, v6, v3
    v_lshrrev_b32 v7, 1, v1
    v_lshlrev_b32 v7, 13, v7
    v_add_u32 v7, v7, v3
    v_add_u32 v7, 16384, v7
    s_mov_b32 s40, 0
    s_mov_b32 s42, 0
    s_add_u32 m0, s40, s36
    s_nop 0
    buffer_load_dwordx4 v4, s[12:15], s42 offen offset:0 lds
    buffer_load_dwordx4 v4, s[12:15], s42 offen offset:1024 lds
    buffer_load_dwordx4 v4, s[12:15], s42 offen offset:2048 lds
    buffer_load_dwordx4 v4, s[12:15], s42 offen offset:3072 lds
    s_add_u32 s41, s40, 16384
    s_add_u32 m0, s41, s36
    s_nop 0
    buffer_load_dwordx4 v5, s[20:23], s42 offen offset:0 lds
    buffer_load_dwordx4 v5, s[20:23], s42 offen offset:1024 lds
    buffer_load_dwordx4 v5, s[20:23], s42 offen offset:2048 lds
    buffer_load_dwordx4 v5, s[20:23], s42 offen offset:3072 lds
    s_mov_b32 s43, 0
L_k_ffn2_kernel_loop:
    s_waitcnt vmcnt(0)
    s_barrier
    s_add_u32 s44, s43, 1
    s_cmp_lt_u32 s44, 7
    s_cbranch_scc0 L_k_ffn2_kernel_nodma
    s_xor_b32 s40, s40, 32768
    s_add_u32 s42, s42, 4096
    s_add_u32 m0, s40, s36
    s_nop 0
    buffer_load_dwordx4 v4, s[12:15], s42 offen offset:0 lds
    buffer_load_dwordx4 v4, s[12:15], s42 offen offset:1024 lds
    buffer_load_dwordx4 v4, s[12:15], s42 offen offset:2048 lds
    buffer_load_dwordx4 v4, s[12:15], s42 offen offset:3072 lds
    s_add_u32 s41, s40, 16384
    s_add_u32 m0, s41, s36
    s_nop 0
    buffer_load_dwordx4 v5, s[20:23], s42 offen offset:0 lds
    buffer_load_dwordx4 v5, s[20:23], s42 offen offset:1024 lds
    buffer_load_dwordx4 v5, s[20:23], s42 offen offset:2048 lds
    buffer_load_dwordx4 v5, s[20:23], s42 offen offset:3072 lds
    s_xor_b32 s40, s40, 32768
L_k_ffn2_kernel_nodma:
    v_add_u32 v8, s40, v6
    v_add_u32 v9, s40, v7
    ds_read_b128 v[16:19], v8 offset:0
    ds_read_b128 v[20:23], v8 offset:4096
    ds_read_b128 v[24:27], v9 offset:0
    ds_read_b128 v[28:31], v9 offset:4096
    ds_read_b128 v[32:35], v8 offset:1024
    ds_read_b128 v[36:39], v8 offset:5120
    ds_read_b128 v[40:43], v9 offset:1024
    ds_read_b128 v[44:47], v9 offset:5120
    s_waitcnt lgkmcnt(4)
    v_mfma_f32_32x32x16_bf16 v[64:79], v[16:19], v[24:27], v[64:79]
    v_mfma_f32_32x32x16_bf16 v[80:95], v[16:19], v[28:31], v[80:95]
    v_mfma_f32_32x32x16_bf16 v[96:111], v[20:23], v[24:27], v[96:111]
    v_mfma_f32_32x32x16_bf16 v[112:127], v[20:23], v[28:31], v[112:127]
    ds_read_b128 v[16:19], v8 offset:2048
    ds_read_b128 v[20:23], v8 offset:6144
    ds_read_b128 v[24:27], v9 offset:2048
    ds_read_b128 v[28:31], v9 offset:6144
    s_waitcnt lgkmcnt(4)
    v_mfma_f32_32x32x16_bf16 v[64:79], v[32:35], v[40:43], v[64:79]
    v_mfma_f32_32x32x16_bf16 v[80:95], v[32:35], v[44:47], v[80:95]
    v_mfma_f32_32x32x16_bf16 v[96:111], v[36:39], v[40:43], v[96:111]
    v_mfma_f32_32x32x16_bf16 v[112:127], v[36:39], v[44:47], v[112:127]
    ds_read_b128 v[32:35], v8 offset:3072
    ds_read_b128 v[36:39], v8 offset:7168
    ds_read_b128 v[40:43], v9 offset:3072
    ds_read_b128 v[44:47], v9 offset:7168
    s_waitcnt lgkmcnt(4)
    v_mfma_f32_32x32x16_bf16 v[64:79], v[16:19], v[24:27], v[64:79]
    v_mfma_f32_32x32x16_bf16 v[80:95], v[16:19], v[28:31], v[80:95]
    v_mfma_f32_32x32x16_bf16 v[96:111], v[20:23], v[24:27], v[96:111]
    v_mfma_f32_32x32x16_bf16 v[112:127], v[20:23], v[28:31], v[112:127]
    s_waitcnt lgkmcnt(0)
    v_mfma_f32_32x32x16_bf16 v[64:79], v[32:35], v[40:43], v[64:79]
    v_mfma_f32_32x32x16_bf16 v[80:95], v[32:35], v[44:47], v[80:95]
    v_mfma_f32_32x32x16_bf16 v[96:111], v[36:39], v[40:43], v[96:111]
    v_mfma_f32_32x32x16_bf16 v[112:127], v[36:39], v[44:47], v[112:127]
    s_xor_b32 s40, s40, 32768
    s_add_u32 s43, s43, 1
    s_cmp_lt_u32 s43, 7
    s_cbranch_scc1 L_k_ffn2_kernel_loop
    s_nop 15
    s_nop 3
    v_and_b32 v10, 31, v2
    v_lshrrev_b32 v11, 5, v2
    s_lshl_b32 s45, s28, 7
    s_lshr_b32 s46, s32, 1
    s_lshl_b32 s46, s46, 6
    s_add_u32 s45, s45, s46
    s_mul_i32 s47, s30, 2048
    s_add_u32 s45, s45, s47
    v_add_u32 v14, s45, v10
    s_mov_b32 s47, 2048
    v_mul_lo_u32 v14, v14, s47
    s_lshl_b32 s45, s29, 7
    s_and_b32 s46, s32, 1
    s_lshl_b32 s46, s46, 6
    s_add_u32 s45, s45, s46
    s_lshl_b32 s45, s45, 2
    v_add_u32 v14, s45, v14
    v_lshl_add_u32 v14, v11, 4, v14
    buffer_store_dwordx4 v[64:67], v14, s[24:27], 0 offen offset:0
    buffer_store_dwordx4 v[68:71], v14, s[24:27], 0 offen offset:32
    buffer_store_dwordx4 v[72:75], v14, s[24:27], 0 offen offset:64
    buffer_store_dwordx4 v[76:79], v14, s[24:27], 0 offen offset:96
    s_mov_b32 s47, 65536
    buffer_store_dwordx4 v[80:83], v14, s[24:27], s47 offen
    s_mov_b32 s47, 65568
    buffer_store_dwordx4 v[84:87], v14, s[24:27], s47 offen
    s_mov_b32 s47, 65600
    buffer_store_dwordx4 v[88:91], v14, s[24:27], s47 offen
    s_mov_b32 s47, 65632
    buffer_store_dwordx4 v[92:95], v14, s[24:27], s47 offen
    buffer_store_dwordx4 v[96:99], v14, s[24:27], 0 offen offset:128
    buffer_store_dwordx4 v[100:103], v14, s[24:27], 0 offen offset:160
    buffer_store_dwordx4 v[104:107], v14, s[24:27], 0 offen offset:192
    buffer_store_dwordx4 v[108:111], v14, s[24:27], 0 offen offset:224
    s_mov_b32 s47, 65664
    buffer_store_dwordx4 v[112:115], v14, s[24:27], s47 offen
    s_mov_b32 s47, 65696
    buffer_store_dwordx4 v[116:119], v14, s[24:27], s47 offen
    s_mov_b32 s47, 65728
    buffer_store_dwordx4 v[120:123], v14, s[24:27], s47 offen
    s_mov_b32 s47, 65760
    buffer_store_dwordx4 v[124:127], v14, s[24:27], s47 offen
    s_waitcnt vmcnt(0)
L_k_ffn2_kernel_done:
    s_endpgm
.globl k_final_kernel
.p2align 8
.type k_final_kernel,@function
k_final_kernel:
    s_cmp_ge_u32 s2, 512
    s_cbranch_scc1 L_k_final_kernel_done
    s_load_dwordx2 s[4:5], s[0:1], 88
    s_load_dwordx2 s[8:9], s[0:1], 104
    s_waitcnt lgkmcnt(0)
    s_mov_b32 s12, s4
    s_and_b32 s13, s5, 0xffff
    s_mov_b32 s14, 2097152
    s_mov_b32 s15, 0x00020000
    s_add_u32 s16, s8, 0
    s_addc_u32 s17, s9, 0
    s_and_b32 s17, s17, 0xffff
    s_mov_b32 s18, 12288
    s_mov_b32 s19, 0x00020000
    s_add_u32 s24, s8, 91226112
    s_addc_u32 s25, s9, 0
    s_and_b32 s25, s25, 0xffff
    s_mov_b32 s26, 16777216
    s_mov_b32 s27, 0x00020000
    s_add_u32 s28, s8, 76546048
    s_addc_u32 s29, s9, 0
    s_and_b32 s29, s29, 0xffff
    s_mov_b32 s30, 4194304
    s_mov_b32 s31, 0x00020000
    v_lshrrev_b32 v1, 6, v0
    s_lshl_b32 s3, s2, 2
    v_add_u32 v1, s3, v1
    v_and_b32 v2, 63, v0
    v_lshlrev_b32 v4, 5, v2
    v_add_u32 v5, 10240, v4
    buffer_load_dwordx4 v[28:31], v5, s[16:19], 0 offen
    buffer_load_dwordx4 v[32:35], v5, s[16:19], 0 offen offset:16
    v_lshlrev_b32 v6, 11, v1
    v_add_u32 v6, v6, v4
    buffer_load_dwordx4 v[40:43], v6, s[28:31], 0 offen
    buffer_load_dwordx4 v[44:47], v6, s[28:31], 0 offen offset:16
    s_mov_b32 s33, 0
    buffer_load_dwordx4 v[48:51], v6, s[24:27], s33 offen
    buffer_load_dwordx4 v[52:55], v6, s[24:27], s33 offen offset:16
    s_mov_b32 s33, 4194304
    buffer_load_dwordx4 v[56:59], v6, s[24:27], s33 offen
    buffer_load_dwordx4 v[60:63], v6, s[24:27], s33 offen offset:16
    s_mov_b32 s33, 8388608
    buffer_load_dwordx4 v[64:67], v6, s[24:27], s33 offen
    buffer_load_dwordx4 v[68:71], v6, s[24:27], s33 offen offset:16
    s_mov_b32 s33, 12582912
    buffer_load_dwordx4 v[72:75], v6, s[24:27], s33 offen
    buffer_load_dwordx4 v[76:79], v6, s[24:27], s33 offen offset:16
    s_waitcnt vmcnt(0)
    v_add_f32 v48, v48, v56
    v_add_f32 v64, v64, v72
    v_add_f32 v48, v48, v64
    v_fmac_f32 v40, v48, v28
    v_add_f32 v49, v49, v57
    v_add_f32 v65, v65, v73
    v_add_f32 v49, v49, v65
    v_fmac_f32 v41, v49, v29
    v_add_f32 v50, v50, v58
    v_add_f32 v66, v66, v74
    v_add_f32 v50, v50, v66
    v_fmac_f32 v42, v50, v30
    v_add_f32 v51, v51, v59
    v_add_f32 v67, v67, v75
    v_add_f32 v51, v51, v67
    v_fmac_f32 v43, v51, v31
    v_add_f32 v52, v52, v60
    v_add_f32 v68, v68, v76
    v_add_f32 v52, v52, v68
    v_fmac_f32 v44, v52, v32
    v_add_f32 v53, v53, v61
    v_add_f32 v69, v69, v77
    v_add_f32 v53, v53, v69
    v_fmac_f32 v45, v53, v33
    v_add_f32 v54, v54, v62
    v_add_f32 v70, v70, v78
    v_add_f32 v54, v54, v70
    v_fmac_f32 v46, v54, v34
    v_add_f32 v55, v55, v63
    v_add_f32 v71, v71, v79
    v_add_f32 v55, v55, v71
    v_fmac_f32 v47, v55, v35
    v_cvt_pk_bf16_f32 v8, v40, v41
    v_cvt_pk_bf16_f32 v9, v42, v43
    v_cvt_pk_bf16_f32 v10, v44, v45
    v_cvt_pk_bf16_f32 v11, v46, v47
    v_lshlrev_b32 v3, 10, v1
    v_lshl_add_u32 v3, v2, 4, v3
    buffer_store_dwordx4 v[8:11], v3, s[12:15], 0 offen
    s_waitcnt vmcnt(0)
L_k_final_kernel_done:
    s_endpgm
.section .rodata,"a"
.p2align 6
.amdhsa_kernel k_prep_kernel
  .amdhsa_next_free_vgpr 64
  .amdhsa_next_free_sgpr 96
  .amdhsa_accum_offset 64
  .amdhsa_group_segment_fixed_size 0
  .amdhsa_kernarg_size 112
  .amdhsa_user_sgpr_count 2
  .amdhsa_user_sgpr_kernarg_segment_ptr 1
  .amdhsa_system_sgpr_workgroup_id_x 1
.end_amdhsa_kernel
.p2align 6
.amdhsa_kernel k_ln1_kernel
  .amdhsa_next_free_vgpr 96
  .amdhsa_next_free_sgpr 96
  .amdhsa_accum_offset 96
  .amdhsa_group_segment_fixed_size 0
  .amdhsa_kernarg_size 112
  .amdhsa_user_sgpr_count 2
  .amdhsa_user_sgpr_kernarg_segment_ptr 1
  .amdhsa_system_sgpr_workgroup_id_x 1
.end_amdhsa_kernel
.p2align 6
.amdhsa_kernel k_qproj_kernel
  .amdhsa_next_free_vgpr 128
  .amdhsa_next_free_sgpr 96
  .amdhsa_accum_offset 128
  .amdhsa_group_segment_fixed_size 0
  .amdhsa_kernarg_size 112
  .amdhsa_user_sgpr_count 2
  .amdhsa_user_sgpr_kernarg_segment_ptr 1
  .amdhsa_system_sgpr_workgroup_id_x 1
.end_amdhsa_kernel
.p2align 6
.amdhsa_kernel k_attn_kernel
  .amdhsa_next_free_vgpr 208
  .amdhsa_next_free_sgpr 96
  .amdhsa_accum_offset 208
  .amdhsa_group_segment_fixed_size 0
  .amdhsa_kernarg_size 112
  .amdhsa_user_sgpr_count 2
  .amdhsa_user_sgpr_kernarg_segment_ptr 1
  .amdhsa_system_sgpr_workgroup_id_x 1
.end_amdhsa_kernel
.p2align 6
.amdhsa_kernel k_oproj_kernel
  .amdhsa_next_free_vgpr 128
  .amdhsa_next_free_sgpr 96
  .amdhsa_accum_offset 128
  .amdhsa_group_segment_fixed_size 0
  .amdhsa_kernarg_size 112
  .amdhsa_user_sgpr_count 2
  .amdhsa_user_sgpr_kernarg_segment_ptr 1
  .amdhsa_system_sgpr_workgroup_id_x 1
.end_amdhsa_kernel
.p2align 6
.amdhsa_kernel k_ln2_kernel
  .amdhsa_next_free_vgpr 96
  .amdhsa_next_free_sgpr 96
  .amdhsa_accum_offset 96
  .amdhsa_group_segment_fixed_size 0
  .amdhsa_kernarg_size 112
  .amdhsa_user_sgpr_count 2
  .amdhsa_user_sgpr_kernarg_segment_ptr 1
  .amdhsa_system_sgpr_workgroup_id_x 1
.end_amdhsa_kernel
.p2align 6
.amdhsa_kernel k_ffn1_kernel
  .amdhsa_next_free_vgpr 128
  .amdhsa_next_free_sgpr 96
  .amdhsa_accum_offset 128
  .amdhsa_group_segment_fixed_size 0
  .amdhsa_kernarg_size 112
  .amdhsa_user_sgpr_count 2
  .amdhsa_user_sgpr_kernarg_segment_ptr 1
  .amdhsa_system_sgpr_workgroup_id_x 1
.end_amdhsa_kernel
.p2align 6
.amdhsa_kernel k_ffn2_kernel
  .amdhsa_next_free_vgpr 128
  .amdhsa_next_free_sgpr 96
  .amdhsa_accum_offset 128
  .amdhsa_group_segment_fixed_size 0
  .amdhsa_kernarg_size 112
  .amdhsa_user_sgpr_count 2
  .amdhsa_user_sgpr_kernarg_segment_ptr 1
  .amdhsa_system_sgpr_workgroup_id_x 1
.end_amdhsa_kernel
.p2align 6
.amdhsa_kernel k_final_kernel
  .amdhsa_next_free_vgpr 96
  .amdhsa_next_free_sgpr 96
  .amdhsa_accum_offset 96
  .amdhsa_group_segment_fixed_size 0
  .amdhsa_kernarg_size 112
  .amdhsa_user_sgpr_count 2
  .amdhsa_user_sgpr_kernarg_segment_ptr 1
  .amdhsa_system_sgpr_workgroup_id_x 1
.end_amdhsa_kernel
```
